```python
import torch

def _softmax(x, axis=-1):
    return torch.softmax(x, dim=axis)
def _gelu(x):
    return torch.nn.functional.gelu(x, approximate="tanh")
def _silu(x):
    return torch.nn.functional.silu(x)
def _sigmoid(x):
    return torch.sigmoid(x)
def _layernorm(x, axis=-1, eps=1e-5):
    m = x.mean(dim=axis, keepdim=True)
    v = x.var(dim=axis, keepdim=True, unbiased=False)
    return (x - m) / torch.sqrt(v + eps)
def _scatter_add(tgt, idx, src, axis=0):
    return tgt.clone().index_add_(axis, idx, src)
def _segment_sum(src, seg, n):
    out = torch.zeros((n,) + src.shape[1:], dtype=src.dtype)
    return out.index_add_(0, seg, src)
def _pad(x, pw):
    flat = tuple(v for pair in reversed(pw) for v in pair)
    return torch.nn.functional.pad(x, flat)

kernel_name = 'recurrent_scan__spectral_gfnet__glu_gated_swiglu__prompt'

def setup_inputs():

    _w = (lambda a: (lambda t: t.to(torch.bfloat16) if t.is_floating_point() else t)(torch.as_tensor(a)))
    def _A_setup():
        B, S, D = 1, 2048, 448
        Df = D // 2 + 1
        return {
            "x": _w((lambda *s: torch.randn(*s, dtype=torch.bfloat16) * 0.2)(B, S, D)),
            "w_r": _w((lambda *s: torch.randn(*s, dtype=torch.bfloat16) * 1.6)(S, Df) * 0.02),
            "w_i": _w((lambda *s: torch.randn(*s, dtype=torch.bfloat16) * 1.6)(S, Df) * 0.02),
        }
    _A_in = _A_setup()

    def _B_setup():
        B, S, D, F = 1, 2048, 448, 1792
        return {
            "x": _w((lambda *s: torch.randn(*s, dtype=torch.bfloat16) * 0.2)(B, S, D)),
            "w1": _w((lambda *s: torch.randn(*s, dtype=torch.bfloat16) * 0.8)(D, F) * (2.0 / D) ** 0.5),
            "w3": _w((lambda *s: torch.randn(*s, dtype=torch.bfloat16) * 0.8)(D, F) * (2.0 / D) ** 0.5),
            "w2": _w((lambda *s: torch.randn(*s, dtype=torch.bfloat16) * 0.8)(F, D) * (2.0 / F) ** 0.5),
        }
    _B_in = _B_setup()

    return {
        "A_x": _A_in["x"],
        "A_w_r": _A_in["w_r"],
        "A_w_i": _A_in["w_i"],
        "B_x": _B_in["x"],
        "B_w1": _B_in["w1"],
        "B_w3": _B_in["w3"],
        "B_w2": _B_in["w2"],
    }

def reference(A_x, A_w_r, A_w_i, B_x, B_w1, B_w3, B_w2):
    def _A_ref(x, w_r, w_i):
        B, S, D = x.shape
        X = (lambda x, axes=(-2,-1): torch.fft.rfft2(x.float(), dim=axes))(x, axes=(-2, -1))
        W = w_r + 1j * w_i
        X = X * W
        y = (lambda x, s, axes=(-2,-1): torch.fft.irfft2(x, s=s, dim=axes).to(torch.bfloat16))(X, (S, D), axes=(-2, -1))
        return y

    def _B_ref(x, w1, w3, w2):
        gate = torch.einsum("bsd,df->bsf", x, w1)
        up = torch.einsum("bsd,df->bsf", x, w3)
        h = _silu(gate) * up
        out = torch.einsum("bsf,fd->bsd", h, w2)
        return out

    x = A_x
    xn = _layernorm(x, axis=-1)
    s = _A_ref(xn, A_w_r, A_w_i)
    g = _silu(_B_ref(xn, B_w1, B_w3, B_w2))
    return x + s * g
```

```asm
; @launch grid=(256,1,1) block=(256,1,1) lds=163840
.amdgcn_target "amdgcn-amd-amdhsa--gfx950"
.text
.globl recurrent_scan__spectral_gfnet__glu_gated_swiglu__prompt_kernel
.p2align 8
.type recurrent_scan__spectral_gfnet__glu_gated_swiglu__prompt_kernel,@function
recurrent_scan__spectral_gfnet__glu_gated_swiglu__prompt_kernel:
    s_cmp_ge_u32 s2, 256
    s_cbranch_scc1 L_end
    s_load_dwordx2 s[8:9], s[0:1], 0
    s_load_dwordx2 s[12:13], s[0:1], 32
    s_load_dwordx2 s[16:17], s[0:1], 40
    s_load_dwordx2 s[20:21], s[0:1], 48
    s_load_dwordx2 s[36:37], s[0:1], 72
    s_load_dwordx2 s[44:45], s[0:1], 64
    s_load_dwordx2 s[24:25], s[0:1], 8
    s_load_dwordx2 s[28:29], s[0:1], 16
    s_load_dwordx2 s[32:33], s[0:1], 56
    v_lshrrev_b32 v2, 6, v0
    v_and_b32 v0, 63, v0
    v_readfirstlane_b32 s48, v2
    v_lshlrev_b32 v1, 4, v0
    v_lshrrev_b32 v23, 3, v0
    v_and_b32 v24, 7, v0
    v_lshrrev_b32 v25, 1, v23
    s_cmp_lt_u32 s2, 32
    s_cbranch_scc1 L_aux
    s_sub_u32 s59, s2, 32
    s_and_b32 s51, s59, 7
    s_bfe_u32 s52, s59, 0x20003
    s_lshr_b32 s54, s59, 5
    s_and_b32 s60, s51, 6
    s_lshl_b32 s55, s60, 1
    s_add_u32 s55, s55, s52
    s_lshl2_add_u32 s55, s55, s48
    s_add_u32 s60, s60, s54
    s_sub_u32 s61, s60, 7
    s_cmp_ge_u32 s60, 7
    s_cselect_b32 s60, s61, s60
    s_lshl_b32 s60, s60, 2
    s_mov_b32 s62, 0x06543210
    s_mov_b32 s63, 0x00054321
    s_lshr_b64 s[62:63], s[62:63], s60
    s_mov_b32 s71, s62
    s_lshl_b32 s58, s48, 12
    s_mul_i32 s70, s55, 896
    v_xor_b32 v26, v24, v25
    v_mul_u32_u24 v2, 57344, v23
    v_lshl_add_u32 v2, v26, 4, v2
    v_xor_b32 v3, 64, v2
    s_mov_b32 s10, 1835008
    s_mov_b32 s11, 0x20000
    s_bfe_u32 s72, s71, 0x30000
    s_lshl_b32 s72, s72, 7
    s_bfe_u32 s73, s71, 0x30004
    s_lshl_b32 s73, s73, 7
    s_waitcnt lgkmcnt(0)
    s_add_u32 s62, s70, s72
    s_add_u32 m0, s58, 0
    s_nop 0
    buffer_load_dwordx4 v2, s[8:11], s62 offen  lds
    s_add_u32 s62, s62, 457728
    buffer_load_dwordx4 v3, s[8:11], s62 offen offset:1024  lds
    s_add_u32 s62, s62, 457728
    buffer_load_dwordx4 v2, s[8:11], s62 offen offset:2048  lds
    s_add_u32 s62, s62, 457728
    buffer_load_dwordx4 v3, s[8:11], s62 offen offset:3072  lds
    s_add_u32 s62, s70, s73
    s_add_u32 m0, s58, 16384
    s_nop 0
    buffer_load_dwordx4 v2, s[8:11], s62 offen  lds
    s_add_u32 s62, s62, 457728
    buffer_load_dwordx4 v3, s[8:11], s62 offen offset:1024  lds
    s_add_u32 s62, s62, 457728
    buffer_load_dwordx4 v2, s[8:11], s62 offen offset:2048  lds
    s_add_u32 s62, s62, 457728
    buffer_load_dwordx4 v3, s[8:11], s62 offen offset:3072  lds
    s_bfe_u32 s74, s71, 0x30008
    s_lshl_b32 s74, s74, 7
    s_bfe_u32 s75, s71, 0x3000c
    s_lshl_b32 s75, s75, 7
    s_bfe_u32 s76, s71, 0x30010
    s_lshl_b32 s76, s76, 7
    s_bfe_u32 s77, s71, 0x30014
    s_lshl_b32 s77, s77, 7
    s_bfe_u32 s78, s71, 0x30018
    s_lshl_b32 s78, s78, 7
    s_and_b32 s50, s51, 1
    s_mul_i32 s50, s50, 7
    s_add_u32 s50, s50, s54
    s_lshl2_add_u32 s53, s51, s52
    s_mov_b32 s57, 0x3f803f80
    s_lshl_b32 s60, s48, 10
    s_lshl4_add_u32 s61, s50, 1
    s_lshl_b32 s63, s48, 4
    v_lshrrev_b32 v26, 5, v0
    v_add_u32 v10, 114688, v1
    v_and_b32 v23, 15, v0
    v_bfe_u32 v24, v0, 4, 1
    v_add_u32 v27, s60, v10
    v_add_u32 v23, s61, v23
    v_lshl_add_u32 v25, v26, 3, s63
    v_cvt_f32_u32 v24, v24
    v_cvt_f32_u32 v23, v23
    v_cvt_f32_u32 v25, v25
    v_mul_f32 v24, 0x3e800000, v24
    v_mul_f32 v23, 0x3b124925, v23
    v_fma_f32 v176, v25, v23, v24
    v_fmamk_f32 v177, v23, 0x3f800000, v176
    v_fmamk_f32 v178, v23, 0x40000000, v176
    v_fmamk_f32 v179, v23, 0x40400000, v176
    v_fmamk_f32 v180, v23, 0x40800000, v176
    v_fmamk_f32 v181, v23, 0x40a00000, v176
    v_fmamk_f32 v182, v23, 0x40c00000, v176
    v_fmamk_f32 v183, v23, 0x40e00000, v176
    v_mul_f32 v23, 0.5, v23
    v_cvt_f32_u32 v184, s72
    v_cvt_f32_u32 v186, s73
    v_cvt_f32_u32 v188, s74
    v_cvt_f32_u32 v190, s75
    v_cvt_f32_u32 v192, s76
    v_cvt_f32_u32 v194, s77
    v_cvt_f32_u32 v196, s78
    v_mul_f32 v184, v184, v23
    v_mul_f32 v186, v186, v23
    v_mul_f32 v188, v188, v23
    v_mul_f32 v190, v190, v23
    v_mul_f32 v192, v192, v23
    v_mul_f32 v194, v194, v23
    v_mul_f32 v196, v196, v23
    v_pk_add_f32 v[144:145], v[176:177], v[184:185] op_sel_hi:[1,0]
    v_pk_add_f32 v[146:147], v[178:179], v[184:185] op_sel_hi:[1,0]
    v_pk_add_f32 v[148:149], v[180:181], v[184:185] op_sel_hi:[1,0]
    v_pk_add_f32 v[150:151], v[182:183], v[184:185] op_sel_hi:[1,0]
    v_cos_f32 v144, v144
    v_cos_f32 v145, v145
    v_cos_f32 v146, v146
    v_cos_f32 v147, v147
    v_cos_f32 v148, v148
    v_cos_f32 v149, v149
    v_cos_f32 v150, v150
    v_cos_f32 v151, v151
    v_pk_add_f32 v[160:161], v[176:177], v[186:187] op_sel_hi:[1,0]
    v_pk_add_f32 v[162:163], v[178:179], v[186:187] op_sel_hi:[1,0]
    v_pk_add_f32 v[164:165], v[180:181], v[186:187] op_sel_hi:[1,0]
    v_pk_add_f32 v[166:167], v[182:183], v[186:187] op_sel_hi:[1,0]
    v_cvt_pk_bf16_f32 v152, v144, v145
    v_cvt_pk_bf16_f32 v153, v146, v147
    v_cvt_pk_bf16_f32 v154, v148, v149
    v_cvt_pk_bf16_f32 v155, v150, v151
    ds_write_b128 v27, v[152:155] offset:0
    v_cos_f32 v160, v160
    v_cos_f32 v161, v161
    v_cos_f32 v162, v162
    v_cos_f32 v163, v163
    v_cos_f32 v164, v164
    v_cos_f32 v165, v165
    v_cos_f32 v166, v166
    v_cos_f32 v167, v167
    v_pk_add_f32 v[144:145], v[176:177], v[188:189] op_sel_hi:[1,0]
    v_pk_add_f32 v[146:147], v[178:179], v[188:189] op_sel_hi:[1,0]
    v_pk_add_f32 v[148:149], v[180:181], v[188:189] op_sel_hi:[1,0]
    v_pk_add_f32 v[150:151], v[182:183], v[188:189] op_sel_hi:[1,0]
    v_cvt_pk_bf16_f32 v168, v160, v161
    v_cvt_pk_bf16_f32 v169, v162, v163
    v_cvt_pk_bf16_f32 v170, v164, v165
    v_cvt_pk_bf16_f32 v171, v166, v167
    ds_write_b128 v27, v[168:171] offset:4096
    v_cos_f32 v144, v144
    v_cos_f32 v145, v145
    v_cos_f32 v146, v146
    v_cos_f32 v147, v147
    v_cos_f32 v148, v148
    v_cos_f32 v149, v149
    v_cos_f32 v150, v150
    v_cos_f32 v151, v151
    v_pk_add_f32 v[160:161], v[176:177], v[190:191] op_sel_hi:[1,0]
    v_pk_add_f32 v[162:163], v[178:179], v[190:191] op_sel_hi:[1,0]
    v_pk_add_f32 v[164:165], v[180:181], v[190:191] op_sel_hi:[1,0]
    v_pk_add_f32 v[166:167], v[182:183], v[190:191] op_sel_hi:[1,0]
    v_cvt_pk_bf16_f32 v152, v144, v145
    v_cvt_pk_bf16_f32 v153, v146, v147
    v_cvt_pk_bf16_f32 v154, v148, v149
    v_cvt_pk_bf16_f32 v155, v150, v151
    ds_write_b128 v27, v[152:155] offset:8192
    v_cos_f32 v160, v160
    v_cos_f32 v161, v161
    v_cos_f32 v162, v162
    v_cos_f32 v163, v163
    v_cos_f32 v164, v164
    v_cos_f32 v165, v165
    v_cos_f32 v166, v166
    v_cos_f32 v167, v167
    v_pk_add_f32 v[144:145], v[176:177], v[192:193] op_sel_hi:[1,0]
    v_pk_add_f32 v[146:147], v[178:179], v[192:193] op_sel_hi:[1,0]
    v_pk_add_f32 v[148:149], v[180:181], v[192:193] op_sel_hi:[1,0]
    v_pk_add_f32 v[150:151], v[182:183], v[192:193] op_sel_hi:[1,0]
    v_cvt_pk_bf16_f32 v168, v160, v161
    v_cvt_pk_bf16_f32 v169, v162, v163
    v_cvt_pk_bf16_f32 v170, v164, v165
    v_cvt_pk_bf16_f32 v171, v166, v167
    ds_write_b128 v27, v[168:171] offset:12288
    v_cos_f32 v144, v144
    v_cos_f32 v145, v145
    v_cos_f32 v146, v146
    v_cos_f32 v147, v147
    v_cos_f32 v148, v148
    v_cos_f32 v149, v149
    v_cos_f32 v150, v150
    v_cos_f32 v151, v151
    v_pk_add_f32 v[160:161], v[176:177], v[194:195] op_sel_hi:[1,0]
    v_pk_add_f32 v[162:163], v[178:179], v[194:195] op_sel_hi:[1,0]
    v_pk_add_f32 v[164:165], v[180:181], v[194:195] op_sel_hi:[1,0]
    v_pk_add_f32 v[166:167], v[182:183], v[194:195] op_sel_hi:[1,0]
    v_cvt_pk_bf16_f32 v152, v144, v145
    v_cvt_pk_bf16_f32 v153, v146, v147
    v_cvt_pk_bf16_f32 v154, v148, v149
    v_cvt_pk_bf16_f32 v155, v150, v151
    ds_write_b128 v27, v[152:155] offset:16384
    v_cos_f32 v160, v160
    v_cos_f32 v161, v161
    v_cos_f32 v162, v162
    v_cos_f32 v163, v163
    v_cos_f32 v164, v164
    v_cos_f32 v165, v165
    v_cos_f32 v166, v166
    v_cos_f32 v167, v167
    v_pk_add_f32 v[144:145], v[176:177], v[196:197] op_sel_hi:[1,0]
    v_pk_add_f32 v[146:147], v[178:179], v[196:197] op_sel_hi:[1,0]
    v_pk_add_f32 v[148:149], v[180:181], v[196:197] op_sel_hi:[1,0]
    v_pk_add_f32 v[150:151], v[182:183], v[196:197] op_sel_hi:[1,0]
    v_cvt_pk_bf16_f32 v168, v160, v161
    v_cvt_pk_bf16_f32 v169, v162, v163
    v_cvt_pk_bf16_f32 v170, v164, v165
    v_cvt_pk_bf16_f32 v171, v166, v167
    ds_write_b128 v27, v[168:171] offset:20480
    v_cos_f32 v144, v144
    v_cos_f32 v145, v145
    v_cos_f32 v146, v146
    v_cos_f32 v147, v147
    v_cos_f32 v148, v148
    v_cos_f32 v149, v149
    v_cos_f32 v150, v150
    v_cos_f32 v151, v151
    v_cvt_pk_bf16_f32 v152, v144, v145
    v_cvt_pk_bf16_f32 v153, v146, v147
    v_cvt_pk_bf16_f32 v154, v148, v149
    v_cvt_pk_bf16_f32 v155, v150, v151
    ds_write_b128 v27, v[152:155] offset:24576
    v_and_b32 v23, 31, v0
    v_lshlrev_b32 v24, 7, v23
    v_add_u32 v24, s58, v24
    v_bfe_u32 v25, v0, 1, 3
    v_xor_b32 v25, v25, v26
    v_lshl_add_u32 v6, v25, 4, v24
    v_xor_b32 v7, 32, v6
    v_xor_b32 v8, 64, v6
    v_xor_b32 v9, 0x60, v6
    v_mov_b32 v28, s57
    v_mov_b32 v29, s57
    v_and_b32 v31, 3, v0
    v_bfe_u32 v24, v0, 2, 2
    v_lshlrev_b32 v23, 7, v24
    v_bfe_u32 v25, v0, 4, 1
    v_lshl_add_u32 v23, v25, 5, v23
    v_and_b32 v25, 3, v0
    v_lshl_add_u32 v23, v25, 3, v23
    v_bfe_u32 v24, v0, 3, 1
    v_lshl_add_u32 v11, v24, 6, v23
    s_add_u32 s62, s70, s74
    s_add_u32 m0, s58, 32768
    s_nop 0
    buffer_load_dwordx4 v2, s[8:11], s62 offen  lds
    s_add_u32 s62, s62, 457728
    buffer_load_dwordx4 v3, s[8:11], s62 offen offset:1024  lds
    v_lshl_add_u32 v11, v26, 10, v11
    s_add_u32 s62, s62, 457728
    buffer_load_dwordx4 v2, s[8:11], s62 offen offset:2048  lds
    v_xor_b32 v12, 64, v11
    s_add_u32 s62, s62, 457728
    buffer_load_dwordx4 v3, s[8:11], s62 offen offset:3072  lds
    v_add_u32 v13, 0x10000, v11
    s_add_u32 s62, s70, s75
    s_add_u32 m0, s58, 49152
    s_nop 0
    buffer_load_dwordx4 v2, s[8:11], s62 offen  lds
    s_add_u32 s62, s62, 457728
    buffer_load_dwordx4 v3, s[8:11], s62 offen offset:1024  lds
    v_add_u32 v14, 0x10000, v12
    s_add_u32 s62, s62, 457728
    buffer_load_dwordx4 v2, s[8:11], s62 offen offset:2048  lds
    v_add_u32 v15, 0x20000, v11
    s_add_u32 s62, s62, 457728
    buffer_load_dwordx4 v3, s[8:11], s62 offen offset:3072  lds
    v_add_u32 v16, 0x20000, v12
    s_waitcnt lgkmcnt(0)
    s_barrier
    s_waitcnt vmcnt(12)
    ds_read_b128 v[32:35], v6 offset:0
    ds_read_b128 a[224:227], v10 offset:0
    ds_read_b128 v[36:39], v7 offset:0
    ds_read_b128 a[228:231], v10 offset:1024
    ds_read_b128 v[40:43], v8 offset:0
    ds_read_b128 a[232:235], v10 offset:2048
    ds_read_b128 v[44:47], v9 offset:0
    ds_read_b128 a[236:239], v10 offset:3072
    s_waitcnt lgkmcnt(0)
    v_mfma_f32_4x4x4_16b_bf16 v[192:195], v[28:29], v[32:33], 0
    v_mfma_f32_4x4x4_16b_bf16 v[196:199], v[32:33], v[32:33], 0
    v_mfma_f32_4x4x4_16b_bf16 v[200:203], v[28:29], v[34:35], 0
    v_mfma_f32_4x4x4_16b_bf16 v[204:207], v[34:35], v[34:35], 0
    v_mfma_f32_32x32x16_bf16 v[224:239], v[32:35], a[224:227], 0
    s_add_u32 s62, s70, s76
    s_add_u32 m0, s58, 65536
    s_nop 0
    buffer_load_dwordx4 v2, s[8:11], s62 offen  lds
    s_add_u32 s62, s62, 457728
    buffer_load_dwordx4 v3, s[8:11], s62 offen offset:1024  lds
    s_mov_b32 s14, 1605632
    s_mov_b32 s15, 0x20000
    s_mov_b32 s18, 1605632
    s_mov_b32 s19, 0x20000
    s_mov_b32 s22, 1605632
    s_mov_b32 s23, 0x20000
    v_lshrrev_b32 v19, 3, v0
    v_mul_u32_u24 v18, 896, v19
    v_mul_u32_u24 v4, 3584, v19
    v_bfe_u32 v17, v0, 4, 1
    v_lshlrev_b32 v17, 2, v17
    v_mfma_f32_4x4x4_16b_bf16 v[192:195], v[28:29], v[36:37], v[192:195]
    v_mfma_f32_4x4x4_16b_bf16 v[196:199], v[36:37], v[36:37], v[196:199]
    v_mfma_f32_4x4x4_16b_bf16 v[200:203], v[28:29], v[38:39], v[200:203]
    v_mfma_f32_4x4x4_16b_bf16 v[204:207], v[38:39], v[38:39], v[204:207]
    v_mfma_f32_32x32x16_bf16 v[224:239], v[36:39], a[228:231], v[224:239]
    s_mul_i32 s60, s48, 57344
    s_lshl_b32 s61, s50, 8
    s_waitcnt vmcnt(10)
    ds_read_b128 v[48:51], v6 offset:16384
    ds_read_b128 a[240:243], v10 offset:4096
    ds_read_b128 v[52:55], v7 offset:16384
    ds_read_b128 a[244:247], v10 offset:5120
    v_and_b32 v19, 7, v0
    v_xor_b32 v17, v17, v19
    v_lshl_add_u32 v18, v17, 4, v18
    v_lshl_add_u32 v4, v17, 4, v4
    v_add_u32 v5, 27648, v4
    v_mfma_f32_4x4x4_16b_bf16 v[192:195], v[28:29], v[40:41], v[192:195]
    v_mfma_f32_4x4x4_16b_bf16 v[196:199], v[40:41], v[40:41], v[196:199]
    v_mfma_f32_4x4x4_16b_bf16 v[200:203], v[28:29], v[42:43], v[200:203]
    v_mfma_f32_4x4x4_16b_bf16 v[204:207], v[42:43], v[42:43], v[204:207]
    v_mfma_f32_32x32x16_bf16 v[224:239], v[40:43], a[232:235], v[224:239]
    ds_read_b128 v[56:59], v8 offset:16384
    ds_read_b128 a[248:251], v10 offset:6144
    ds_read_b128 v[60:63], v9 offset:16384
    ds_read_b128 a[252:255], v10 offset:7168
    s_add_u32 s62, s62, 457728
    buffer_load_dwordx4 v2, s[8:11], s62 offen offset:2048  lds
    s_add_u32 s62, s62, 457728
    buffer_load_dwordx4 v3, s[8:11], s62 offen offset:3072  lds
    s_add_u32 s60, s60, s61
    s_mul_i32 s79, s72, 1792
    s_add_u32 s79, s79, s60
    s_mul_i32 s80, s73, 1792
    s_add_u32 s80, s80, s60
    s_mul_i32 s81, s74, 1792
    s_add_u32 s81, s81, s60
    v_mfma_f32_4x4x4_16b_bf16 v[192:195], v[28:29], v[44:45], v[192:195]
    v_mfma_f32_4x4x4_16b_bf16 v[196:199], v[44:45], v[44:45], v[196:199]
    v_mfma_f32_4x4x4_16b_bf16 v[200:203], v[28:29], v[46:47], v[200:203]
    v_mfma_f32_4x4x4_16b_bf16 v[204:207], v[46:47], v[46:47], v[204:207]
    v_mfma_f32_32x32x16_bf16 v[224:239], v[44:47], a[236:239], v[224:239]
    s_mul_i32 s82, s75, 1792
    s_add_u32 s82, s82, s60
    s_mul_i32 s83, s76, 1792
    s_add_u32 s83, s83, s60
    s_mul_i32 s84, s77, 1792
    s_add_u32 s84, s84, s60
    s_mul_i32 s85, s78, 1792
    s_add_u32 s85, s85, s60
    s_lshl2_add_u32 s69, s53, s48
    s_mul_i32 s64, s69, 14336
    s_lshl_b32 s60, s54, 7
    s_add_u32 s62, s70, s77
    s_add_u32 m0, s58, 81920
    s_nop 0
    buffer_load_dwordx4 v2, s[8:11], s62 offen  lds
    s_add_u32 s62, s62, 457728
    buffer_load_dwordx4 v3, s[8:11], s62 offen offset:1024  lds
    s_add_u32 s62, s62, 457728
    buffer_load_dwordx4 v2, s[8:11], s62 offen offset:2048  lds
    s_add_u32 s62, s62, 457728
    buffer_load_dwordx4 v3, s[8:11], s62 offen offset:3072  lds
    s_waitcnt lgkmcnt(0)
    v_mfma_f32_4x4x4_16b_bf16 v[192:195], v[28:29], v[48:49], v[192:195]
    v_mfma_f32_4x4x4_16b_bf16 v[196:199], v[48:49], v[48:49], v[196:199]
    v_mfma_f32_4x4x4_16b_bf16 v[200:203], v[28:29], v[50:51], v[200:203]
    v_mfma_f32_4x4x4_16b_bf16 v[204:207], v[50:51], v[50:51], v[204:207]
    v_mfma_f32_32x32x16_bf16 v[224:239], v[48:51], a[240:243], v[224:239]
    s_add_u32 s62, s70, s78
    s_add_u32 m0, s58, 98304
    s_nop 0
    buffer_load_dwordx4 v2, s[8:11], s62 offen  lds
    s_add_u32 s64, s64, s60
    s_lshr_b32 s60, s53, 1
    s_lshl_b32 s60, s60, 1
    s_and_b32 s61, s48, 1
    s_add_u32 s60, s60, s61
    s_lshl_b32 s65, s60, 13
    s_and_b32 s60, s60, 3
    s_lshl_b32 s68, s60, 9
    s_bfe_u32 s61, s69, 0x20001
    s_lshl_b32 s60, s61, 11
    s_add_u32 s65, s65, s60
    v_mfma_f32_4x4x4_16b_bf16 v[192:195], v[28:29], v[52:53], v[192:195]
    v_mfma_f32_4x4x4_16b_bf16 v[196:199], v[52:53], v[52:53], v[196:199]
    v_mfma_f32_4x4x4_16b_bf16 v[200:203], v[28:29], v[54:55], v[200:203]
    v_mfma_f32_4x4x4_16b_bf16 v[204:207], v[54:55], v[54:55], v[204:207]
    v_mfma_f32_32x32x16_bf16 v[224:239], v[52:55], a[244:247], v[224:239]
    s_and_b32 s60, s53, 28
    s_add_u32 s60, s60, s61
    s_lshl4_add_u32 s68, s60, s68
    s_mul_i32 s60, s54, 229376
    s_add_u32 s60, s60, 11010048
    s_add_u32 s65, s65, s60
    s_lshl_b32 s60, s54, 11
    s_waitcnt vmcnt(13)
    ds_read_b128 v[64:67], v6 offset:32768
    ds_read_b128 a[224:227], v10 offset:8192
    ds_read_b128 v[68:71], v7 offset:32768
    ds_read_b128 a[228:231], v10 offset:9216
    v_mfma_f32_4x4x4_16b_bf16 v[192:195], v[28:29], v[56:57], v[192:195]
    v_mfma_f32_4x4x4_16b_bf16 v[196:199], v[56:57], v[56:57], v[196:199]
    v_mfma_f32_4x4x4_16b_bf16 v[200:203], v[28:29], v[58:59], v[200:203]
    v_mfma_f32_4x4x4_16b_bf16 v[204:207], v[58:59], v[58:59], v[204:207]
    v_mfma_f32_32x32x16_bf16 v[224:239], v[56:59], a[248:251], v[224:239]
    ds_read_b128 v[72:75], v8 offset:32768
    ds_read_b128 a[232:235], v10 offset:10240
    ds_read_b128 v[76:79], v9 offset:32768
    ds_read_b128 a[236:239], v10 offset:11264
    s_add_u32 s62, s62, 457728
    buffer_load_dwordx4 v3, s[8:11], s62 offen offset:1024  lds
    s_add_u32 s60, s60, 12730368
    s_add_u32 s68, s68, s60
    s_cmp_lt_u32 s69, 112
    s_cselect_b32 s65, s65, 12910592
    s_cselect_b32 s68, s68, 12910592
    s_getpc_b64 s[40:41]
    s_add_u32 s40, s40, TABS@rel32@lo+4
    s_addc_u32 s41, s41, TABS@rel32@hi+12
    s_mov_b32 s42, 4096
    s_mov_b32 s43, 0x20000
    s_mov_b32 s46, 256
    v_mfma_f32_4x4x4_16b_bf16 v[192:195], v[28:29], v[60:61], v[192:195]
    v_mfma_f32_4x4x4_16b_bf16 v[196:199], v[60:61], v[60:61], v[196:199]
    v_mfma_f32_4x4x4_16b_bf16 v[200:203], v[28:29], v[62:63], v[200:203]
    v_mfma_f32_4x4x4_16b_bf16 v[204:207], v[62:63], v[62:63], v[204:207]
    v_mfma_f32_32x32x16_bf16 v[224:239], v[60:63], a[252:255], v[224:239]
    s_mov_b32 s47, 0x20000
    s_mov_b32 s38, 12910592
    s_mov_b32 s39, 0x20000
    s_mov_b32 s34, 1835008
    s_mov_b32 s35, 0x20000
    s_mul_i32 s66, s55, 114688
    s_lshl_b32 s60, s50, 13
    s_add_u32 s66, s66, s60
    s_add_u32 s66, s66, 0
    s_add_u32 s67, s66, 4096
    s_mov_b32 s56, 0xffff0000
    s_add_u32 s62, s62, 457728
    buffer_load_dwordx4 v2, s[8:11], s62 offen offset:2048  lds
    s_add_u32 s62, s62, 457728
    buffer_load_dwordx4 v3, s[8:11], s62 offen offset:3072  lds
    s_waitcnt lgkmcnt(0)
    v_mfma_f32_4x4x4_16b_bf16 v[192:195], v[28:29], v[64:65], v[192:195]
    v_mfma_f32_4x4x4_16b_bf16 v[196:199], v[64:65], v[64:65], v[196:199]
    v_mfma_f32_4x4x4_16b_bf16 v[200:203], v[28:29], v[66:67], v[200:203]
    v_mfma_f32_4x4x4_16b_bf16 v[204:207], v[66:67], v[66:67], v[204:207]
    v_mfma_f32_32x32x16_bf16 v[224:239], v[64:67], a[224:227], v[224:239]
    s_add_u32 m0, s58, 147456
    s_nop 0
    buffer_load_dwordx4 v4, s[12:15], s79 offen  lds
    v_bfe_u32 v23, v0, 1, 4
    v_lshlrev_b32 v22, 13, v23
    v_lshl_add_u32 v22, v26, 5, v22
    v_and_b32 v27, 1, v0
    v_lshl_add_u32 v22, v27, 4, v22
    v_sub_u32 v25, 32, v23
    v_cmp_eq_u32 vcc, 0, v23
    v_mfma_f32_4x4x4_16b_bf16 v[192:195], v[28:29], v[68:69], v[192:195]
    v_mfma_f32_4x4x4_16b_bf16 v[196:199], v[68:69], v[68:69], v[196:199]
    v_mfma_f32_4x4x4_16b_bf16 v[200:203], v[28:29], v[70:71], v[200:203]
    v_mfma_f32_4x4x4_16b_bf16 v[204:207], v[70:71], v[70:71], v[204:207]
    v_mfma_f32_32x32x16_bf16 v[224:239], v[68:71], a[228:231], v[224:239]
    s_waitcnt vmcnt(13)
    ds_read_b128 v[80:83], v6 offset:49152
    ds_read_b128 a[240:243], v10 offset:12288
    ds_read_b128 v[84:87], v7 offset:49152
    ds_read_b128 a[244:247], v10 offset:13312
    ds_read_b128 v[88:91], v8 offset:49152
    v_lshlrev_b32 v24, 8, v26
    v_add_u32 v24, s55, v24
    v_mfma_f32_4x4x4_16b_bf16 v[192:195], v[28:29], v[72:73], v[192:195]
    v_mfma_f32_4x4x4_16b_bf16 v[196:199], v[72:73], v[72:73], v[196:199]
    v_mfma_f32_4x4x4_16b_bf16 v[200:203], v[28:29], v[74:75], v[200:203]
    v_mfma_f32_4x4x4_16b_bf16 v[204:207], v[74:75], v[74:75], v[204:207]
    v_mfma_f32_32x32x16_bf16 v[224:239], v[72:75], a[232:235], v[224:239]
    ds_read_b128 a[248:251], v10 offset:14336
    ds_read_b128 v[92:95], v9 offset:49152
    ds_read_b128 a[252:255], v10 offset:15360
    buffer_load_dwordx4 v5, s[12:15], s79 offen offset:1024  lds
    v_cndmask_b32 v25, v25, 16, vcc
    v_cmp_eq_u32 vcc, 0, v27
    v_cvt_f32_u32 v24, v24
    v_mul_f32 v24, 0x3a000000, v24
    v_mfma_f32_4x4x4_16b_bf16 v[192:195], v[28:29], v[76:77], v[192:195]
    v_mfma_f32_4x4x4_16b_bf16 v[196:199], v[76:77], v[76:77], v[196:199]
    v_mfma_f32_4x4x4_16b_bf16 v[200:203], v[28:29], v[78:79], v[200:203]
    v_mfma_f32_4x4x4_16b_bf16 v[204:207], v[78:79], v[78:79], v[204:207]
    v_mfma_f32_32x32x16_bf16 v[224:239], v[76:79], a[236:239], v[224:239]
    s_add_u32 m0, s58, 149504
    s_nop 0
    buffer_load_dwordx4 v4, s[16:19], s79 offen  lds
    buffer_load_dwordx4 v5, s[16:19], s79 offen offset:1024  lds
    v_cndmask_b32 v23, v25, v23, vcc
    v_cvt_f32_u32 v23, v23
    v_mul_f32 v24, v23, v24
    v_mul_f32 v23, 0x3d000000, v23
    v_fmamk_f32 v144, v23, 0x0, v24
    v_fmamk_f32 v145, v23, 0x3f800000, v24
    s_add_u32 m0, s58, 32768
    s_nop 0
    buffer_load_dwordx4 v18, s[20:23], s64 offen  lds
    s_add_u32 s64, s64, 6144
    buffer_load_dwordx4 v18, s[20:23], s64 offen offset:1024  lds
    s_waitcnt lgkmcnt(0)
    v_mfma_f32_4x4x4_16b_bf16 v[192:195], v[28:29], v[80:81], v[192:195]
    v_mfma_f32_4x4x4_16b_bf16 v[196:199], v[80:81], v[80:81], v[196:199]
    v_mfma_f32_4x4x4_16b_bf16 v[200:203], v[28:29], v[82:83], v[200:203]
    v_mfma_f32_4x4x4_16b_bf16 v[204:207], v[82:83], v[82:83], v[204:207]
    v_mfma_f32_32x32x16_bf16 v[224:239], v[80:83], a[240:243], v[224:239]
    v_cos_f32 v146, v144
    v_cos_f32 v147, v145
    v_sin_f32 v144, v144
    v_sin_f32 v145, v145
    v_cvt_pk_bf16_f32 v146, v146, v147
    v_cvt_pk_bf16_f32 v144, v144, v145
    v_accvgpr_write_b32 a200, v146
    v_accvgpr_write_b32 a208, v144
    v_mfma_f32_4x4x4_16b_bf16 v[192:195], v[28:29], v[84:85], v[192:195]
    v_mfma_f32_4x4x4_16b_bf16 v[196:199], v[84:85], v[84:85], v[196:199]
    v_mfma_f32_4x4x4_16b_bf16 v[200:203], v[28:29], v[86:87], v[200:203]
    v_mfma_f32_4x4x4_16b_bf16 v[204:207], v[86:87], v[86:87], v[204:207]
    v_mfma_f32_32x32x16_bf16 v[224:239], v[84:87], a[244:247], v[224:239]
    s_waitcnt vmcnt(14)
    v_fmamk_f32 v144, v23, 0x40000000, v24
    v_add_u32 v6, 0x10000, v6
    v_add_u32 v7, 0x10000, v7
    v_add_u32 v8, 0x10000, v8
    v_add_u32 v9, 0x10000, v9
    v_mfma_f32_4x4x4_16b_bf16 v[192:195], v[28:29], v[88:89], v[192:195]
    v_mfma_f32_4x4x4_16b_bf16 v[196:199], v[88:89], v[88:89], v[196:199]
    v_mfma_f32_4x4x4_16b_bf16 v[200:203], v[28:29], v[90:91], v[200:203]
    v_mfma_f32_4x4x4_16b_bf16 v[204:207], v[90:91], v[90:91], v[204:207]
    v_mfma_f32_32x32x16_bf16 v[224:239], v[88:91], a[248:251], v[224:239]
    ds_read_b128 v[96:99], v6 offset:0
    ds_read_b128 a[224:227], v10 offset:16384
    ds_read_b128 v[100:103], v7 offset:0
    ds_read_b128 a[228:231], v10 offset:17408
    ds_read_b128 v[104:107], v8 offset:0
    ds_read_b128 a[232:235], v10 offset:18432
    ds_read_b128 v[108:111], v9 offset:0
    ds_read_b128 a[236:239], v10 offset:19456
    v_fmamk_f32 v145, v23, 0x40400000, v24
    v_cos_f32 v146, v144
    v_mfma_f32_4x4x4_16b_bf16 v[192:195], v[28:29], v[92:93], v[192:195]
    v_mfma_f32_4x4x4_16b_bf16 v[196:199], v[92:93], v[92:93], v[196:199]
    v_mfma_f32_4x4x4_16b_bf16 v[200:203], v[28:29], v[94:95], v[200:203]
    v_mfma_f32_4x4x4_16b_bf16 v[204:207], v[94:95], v[94:95], v[204:207]
    v_mfma_f32_32x32x16_bf16 v[224:239], v[92:95], a[252:255], v[224:239]
    v_cos_f32 v147, v145
    v_sin_f32 v144, v144
    v_sin_f32 v145, v145
    v_cvt_pk_bf16_f32 v146, v146, v147
    v_cvt_pk_bf16_f32 v144, v144, v145
    v_accvgpr_write_b32 a201, v146
    v_accvgpr_write_b32 a209, v144
    v_fmamk_f32 v144, v23, 0x41000000, v24
    buffer_load_dwordx4 a[216:219], v1, s[40:43], 0 offen offset:2048
    buffer_load_dwordx4 a[220:223], v1, s[40:43], 0 offen offset:3072
    s_waitcnt lgkmcnt(0)
    v_mfma_f32_4x4x4_16b_bf16 v[192:195], v[28:29], v[96:97], v[192:195]
    v_mfma_f32_4x4x4_16b_bf16 v[196:199], v[96:97], v[96:97], v[196:199]
    v_mfma_f32_4x4x4_16b_bf16 v[200:203], v[28:29], v[98:99], v[200:203]
    v_mfma_f32_4x4x4_16b_bf16 v[204:207], v[98:99], v[98:99], v[204:207]
    v_mfma_f32_32x32x16_bf16 v[224:239], v[96:99], a[224:227], v[224:239]
    s_add_u32 m0, s58, 0
    s_nop 0
    buffer_load_dwordx4 v4, s[12:15], s80 offen  lds
    v_fmamk_f32 v145, v23, 0x41100000, v24
    v_cos_f32 v146, v144
    v_cos_f32 v147, v145
    v_sin_f32 v144, v144
    v_sin_f32 v145, v145
    v_cvt_pk_bf16_f32 v146, v146, v147
    v_cvt_pk_bf16_f32 v144, v144, v145
    v_mfma_f32_4x4x4_16b_bf16 v[192:195], v[28:29], v[100:101], v[192:195]
    v_mfma_f32_4x4x4_16b_bf16 v[196:199], v[100:101], v[100:101], v[196:199]
    v_mfma_f32_4x4x4_16b_bf16 v[200:203], v[28:29], v[102:103], v[200:203]
    v_mfma_f32_4x4x4_16b_bf16 v[204:207], v[102:103], v[102:103], v[204:207]
    v_mfma_f32_32x32x16_bf16 v[224:239], v[100:103], a[228:231], v[224:239]
    s_waitcnt vmcnt(13)
    ds_read_b128 v[112:115], v6 offset:16384
    ds_read_b128 a[240:243], v10 offset:20480
    ds_read_b128 v[116:119], v7 offset:16384
    ds_read_b128 a[244:247], v10 offset:21504
    v_accvgpr_write_b32 a202, v146
    v_accvgpr_write_b32 a210, v144
    v_fmamk_f32 v144, v23, 0x41200000, v24
    v_mfma_f32_4x4x4_16b_bf16 v[192:195], v[28:29], v[104:105], v[192:195]
    v_mfma_f32_4x4x4_16b_bf16 v[196:199], v[104:105], v[104:105], v[196:199]
    v_mfma_f32_4x4x4_16b_bf16 v[200:203], v[28:29], v[106:107], v[200:203]
    v_mfma_f32_4x4x4_16b_bf16 v[204:207], v[106:107], v[106:107], v[204:207]
    v_mfma_f32_32x32x16_bf16 v[224:239], v[104:107], a[232:235], v[224:239]
    ds_read_b128 v[120:123], v8 offset:16384
    ds_read_b128 a[248:251], v10 offset:22528
    ds_read_b128 v[124:127], v9 offset:16384
    ds_read_b128 a[252:255], v10 offset:23552
    buffer_load_dwordx4 v5, s[12:15], s80 offen offset:1024  lds
    v_fmamk_f32 v145, v23, 0x41300000, v24
    v_cos_f32 v146, v144
    v_cos_f32 v147, v145
    v_mfma_f32_4x4x4_16b_bf16 v[192:195], v[28:29], v[108:109], v[192:195]
    v_mfma_f32_4x4x4_16b_bf16 v[196:199], v[108:109], v[108:109], v[196:199]
    v_mfma_f32_4x4x4_16b_bf16 v[200:203], v[28:29], v[110:111], v[200:203]
    v_mfma_f32_4x4x4_16b_bf16 v[204:207], v[110:111], v[110:111], v[204:207]
    v_mfma_f32_32x32x16_bf16 v[224:239], v[108:111], a[236:239], v[224:239]
    s_add_u32 m0, s58, 2048
    s_nop 0
    buffer_load_dwordx4 v4, s[16:19], s80 offen  lds
    buffer_load_dwordx4 v5, s[16:19], s80 offen offset:1024  lds
    v_sin_f32 v144, v144
    v_sin_f32 v145, v145
    v_cvt_pk_bf16_f32 v146, v146, v147
    v_cvt_pk_bf16_f32 v144, v144, v145
    v_accvgpr_write_b32 a203, v146
    v_accvgpr_write_b32 a211, v144
    v_fmamk_f32 v144, v23, 0x41800000, v24
    s_waitcnt lgkmcnt(0)
    v_mfma_f32_4x4x4_16b_bf16 v[192:195], v[28:29], v[112:113], v[192:195]
    v_mfma_f32_4x4x4_16b_bf16 v[196:199], v[112:113], v[112:113], v[196:199]
    v_mfma_f32_4x4x4_16b_bf16 v[200:203], v[28:29], v[114:115], v[200:203]
    v_mfma_f32_4x4x4_16b_bf16 v[204:207], v[114:115], v[114:115], v[204:207]
    v_mfma_f32_32x32x16_bf16 v[224:239], v[112:115], a[240:243], v[224:239]
    s_add_u32 m0, s58, 16384
    s_nop 0
    buffer_load_dwordx4 v4, s[12:15], s81 offen  lds
    v_fmamk_f32 v145, v23, 0x41880000, v24
    v_cos_f32 v146, v144
    v_cos_f32 v147, v145
    v_sin_f32 v144, v144
    v_sin_f32 v145, v145
    v_cvt_pk_bf16_f32 v146, v146, v147
    v_cvt_pk_bf16_f32 v144, v144, v145
    v_mfma_f32_4x4x4_16b_bf16 v[192:195], v[28:29], v[116:117], v[192:195]
    v_mfma_f32_4x4x4_16b_bf16 v[196:199], v[116:117], v[116:117], v[196:199]
    v_mfma_f32_4x4x4_16b_bf16 v[200:203], v[28:29], v[118:119], v[200:203]
    v_mfma_f32_4x4x4_16b_bf16 v[204:207], v[118:119], v[118:119], v[204:207]
    v_mfma_f32_32x32x16_bf16 v[224:239], v[116:119], a[244:247], v[224:239]
    s_waitcnt vmcnt(13)
    ds_read_b128 v[128:131], v6 offset:32768
    ds_read_b128 a[224:227], v10 offset:24576
    ds_read_b128 v[132:135], v7 offset:32768
    ds_read_b128 a[228:231], v10 offset:25600
    ds_read_b128 v[136:139], v8 offset:32768
    v_accvgpr_write_b32 a204, v146
    v_accvgpr_write_b32 a212, v144
    v_mfma_f32_4x4x4_16b_bf16 v[192:195], v[28:29], v[120:121], v[192:195]
    v_mfma_f32_4x4x4_16b_bf16 v[196:199], v[120:121], v[120:121], v[196:199]
    v_mfma_f32_4x4x4_16b_bf16 v[200:203], v[28:29], v[122:123], v[200:203]
    v_mfma_f32_4x4x4_16b_bf16 v[204:207], v[122:123], v[122:123], v[204:207]
    v_mfma_f32_32x32x16_bf16 v[224:239], v[120:123], a[248:251], v[224:239]
    ds_read_b128 a[232:235], v10 offset:26624
    ds_read_b128 v[140:143], v9 offset:32768
    ds_read_b128 a[236:239], v10 offset:27648
    buffer_load_dwordx4 v5, s[12:15], s81 offen offset:1024  lds
    v_fmamk_f32 v144, v23, 0x41900000, v24
    v_fmamk_f32 v145, v23, 0x41980000, v24
    v_cos_f32 v146, v144
    v_cos_f32 v147, v145
    v_mfma_f32_4x4x4_16b_bf16 v[192:195], v[28:29], v[124:125], v[192:195]
    v_mfma_f32_4x4x4_16b_bf16 v[196:199], v[124:125], v[124:125], v[196:199]
    v_mfma_f32_4x4x4_16b_bf16 v[200:203], v[28:29], v[126:127], v[200:203]
    v_mfma_f32_4x4x4_16b_bf16 v[204:207], v[126:127], v[126:127], v[204:207]
    v_mfma_f32_32x32x16_bf16 v[224:239], v[124:127], a[252:255], v[224:239]
    s_add_u32 m0, s58, 18432
    s_nop 0
    buffer_load_dwordx4 v4, s[16:19], s81 offen  lds
    buffer_load_dwordx4 v5, s[16:19], s81 offen offset:1024  lds
    v_sin_f32 v144, v144
    v_sin_f32 v145, v145
    v_cvt_pk_bf16_f32 v146, v146, v147
    v_cvt_pk_bf16_f32 v144, v144, v145
    v_accvgpr_write_b32 a205, v146
    v_accvgpr_write_b32 a213, v144
    s_waitcnt lgkmcnt(0)
    v_mfma_f32_4x4x4_16b_bf16 v[192:195], v[28:29], v[128:129], v[192:195]
    v_mfma_f32_4x4x4_16b_bf16 v[196:199], v[128:129], v[128:129], v[196:199]
    v_mfma_f32_4x4x4_16b_bf16 v[200:203], v[28:29], v[130:131], v[200:203]
    v_mfma_f32_4x4x4_16b_bf16 v[204:207], v[130:131], v[130:131], v[204:207]
    v_mfma_f32_32x32x16_bf16 v[224:239], v[128:131], a[224:227], v[224:239]
    v_fmamk_f32 v144, v23, 0x41c00000, v24
    v_fmamk_f32 v145, v23, 0x41c80000, v24
    v_cos_f32 v146, v144
    v_cos_f32 v147, v145
    v_sin_f32 v144, v144
    v_sin_f32 v145, v145
    v_cvt_pk_bf16_f32 v146, v146, v147
    v_mfma_f32_4x4x4_16b_bf16 v[192:195], v[28:29], v[132:133], v[192:195]
    v_mfma_f32_4x4x4_16b_bf16 v[196:199], v[132:133], v[132:133], v[196:199]
    v_mfma_f32_4x4x4_16b_bf16 v[200:203], v[28:29], v[134:135], v[200:203]
    v_mfma_f32_4x4x4_16b_bf16 v[204:207], v[134:135], v[134:135], v[204:207]
    v_mfma_f32_32x32x16_bf16 v[224:239], v[132:135], a[228:231], v[224:239]
    v_cvt_pk_bf16_f32 v144, v144, v145
    v_accvgpr_write_b32 a206, v146
    v_accvgpr_write_b32 a214, v144
    v_fmamk_f32 v144, v23, 0x41d00000, v24
    v_fmamk_f32 v145, v23, 0x41d80000, v24
    v_cos_f32 v146, v144
    v_cos_f32 v147, v145
    v_sin_f32 v144, v144
    v_mfma_f32_4x4x4_16b_bf16 v[192:195], v[28:29], v[136:137], v[192:195]
    v_mfma_f32_4x4x4_16b_bf16 v[196:199], v[136:137], v[136:137], v[196:199]
    v_mfma_f32_4x4x4_16b_bf16 v[200:203], v[28:29], v[138:139], v[200:203]
    v_mfma_f32_4x4x4_16b_bf16 v[204:207], v[138:139], v[138:139], v[204:207]
    v_mfma_f32_32x32x16_bf16 v[224:239], v[136:139], a[232:235], v[224:239]
    s_waitcnt vmcnt(10)
    v_sin_f32 v145, v145
    v_cvt_pk_bf16_f32 v146, v146, v147
    v_cvt_pk_bf16_f32 v144, v144, v145
    v_accvgpr_write_b32 a207, v146
    v_accvgpr_write_b32 a215, v144
    v_bfe_u32 v21, v0, 5, 1
    v_lshlrev_b32 v21, 9, v21
    v_mfma_f32_4x4x4_16b_bf16 v[192:195], v[28:29], v[140:141], v[192:195]
    v_mfma_f32_4x4x4_16b_bf16 v[196:199], v[140:141], v[140:141], v[196:199]
    v_mfma_f32_4x4x4_16b_bf16 v[200:203], v[28:29], v[142:143], v[200:203]
    v_mfma_f32_4x4x4_16b_bf16 v[204:207], v[142:143], v[142:143], v[204:207]
    v_mfma_f32_32x32x16_bf16 v[224:239], v[140:143], a[236:239], v[224:239]
    v_sub_u32 v21, v11, v21
    v_add_u32 v21, 32768, v21
    v_add_u32 v21, s58, v21
    ds_read_b64_tr_b16 v[240:241], v21
    ds_read_b64_tr_b16 v[242:243], v21 offset:1024
    v_xor_b32 v21, 64, v21
    ds_read_b64_tr_b16 v[244:245], v21
    ds_read_b64_tr_b16 v[246:247], v21 offset:1024
    v_and_b32 v18, 15, v0
    v_lshlrev_b32 v18, 2, v18
    buffer_load_dword v17, v18, s[44:47], 0 offen offset:128 sc1
    v_mov_b32 v2, 1
    v_mov_b32 v3, 0
    s_barrier
    s_waitcnt lgkmcnt(2)
    buffer_store_dwordx4 v[240:243], v1, s[36:39], s65 offen offset:0 sc1
    s_waitcnt lgkmcnt(0)
    buffer_store_dwordx4 v[244:247], v1, s[36:39], s65 offen offset:1024 sc1
    ds_read_b64_tr_b16 a[224:225], v15 offset:16384
    ds_read_b64_tr_b16 a[226:227], v15 offset:16896
    ds_read_b64_tr_b16 a[228:229], v15 offset:18432
    ds_read_b64_tr_b16 a[230:231], v15 offset:18944
    ds_read_b64_tr_b16 a[232:233], v16 offset:16384
    ds_read_b64_tr_b16 a[234:235], v16 offset:16896
    ds_read_b64_tr_b16 a[236:237], v16 offset:18432
    ds_read_b64_tr_b16 a[238:239], v16 offset:18944
    s_lshl_b32 s60, s48, 7
    s_add_u32 s60, s60, 143360
    v_add_f32 v28, v192, v200
    v_cmp_eq_u32 vcc, 1, v31
    v_mov_b32 v29, v28
    v_cmp_eq_u32 s[62:63], 2, v31
    v_cmp_eq_u32 s[4:5], 3, v31
    v_permlane32_swap_b32 v28, v29
    v_pk_add_f32 v[196:197], v[196:197], v[204:205]
    v_add_f32 v28, v28, v29
    v_pk_add_f32 v[198:199], v[198:199], v[206:207]
    v_mul_f32 v240, 0xbb124925, v28
    v_cndmask_b32 v30, v196, v197, vcc
    v_mov_b32 v241, v240
    v_cndmask_b32 v30, v30, v198, s[62:63]
    v_pk_mov_b32 v[242:243], v[240:241], v[240:241] op_sel:[0,1]
    v_pk_mov_b32 v[244:245], v[240:241], v[240:241] op_sel:[0,1]
    v_pk_mov_b32 v[246:247], v[240:241], v[240:241] op_sel:[0,1]
    v_pk_mov_b32 v[248:249], v[240:241], v[240:241] op_sel:[0,1]
    v_pk_mov_b32 v[250:251], v[240:241], v[240:241] op_sel:[0,1]
    v_pk_mov_b32 v[252:253], v[240:241], v[240:241] op_sel:[0,1]
    v_pk_mov_b32 v[254:255], v[240:241], v[240:241] op_sel:[0,1]
    s_waitcnt vmcnt(12)
    s_nop 0
    v_mfma_f32_32x32x16_bf16 v[144:159], a[216:219], v[32:35], v[240:255]
    v_cndmask_b32 v30, v30, v199, s[4:5]
    v_and_b32 v23, 31, v0
    v_mov_b32 v31, v30
    v_lshl_add_u32 v23, v23, 2, s60
    s_waitcnt vmcnt(11)
    v_mfma_f32_32x32x16_bf16 v[144:159], a[220:223], v[36:39], v[144:159]
    v_lshl_add_u32 v19, v26, 4, s60
    v_permlane32_swap_b32 v30, v31
    v_add_f32 v30, v30, v31
    v_mul_f32 v30, 0x3b124925, v30
    v_mfma_f32_32x32x16_bf16 v[160:175], a[216:219], v[40:43], v[240:255]
    v_fma_f32 v30, -v240, v240, v30
    v_max_f32 v30, 0, v30
    v_add_f32 v21, 0x3727c5ac, v30
    v_rsq_f32 v29, v21
    v_mfma_f32_32x32x16_bf16 v[160:175], a[220:223], v[44:47], v[160:175]
    ds_write_b32 v23, v29
    v_mul_f32 v20, 0xbfb8aa3b, v29
    v_cvt_pk_bf16_f32 v32, v144, v145
    v_cvt_pk_bf16_f32 v33, v146, v147
    v_cvt_pk_bf16_f32 v34, v148, v149
    v_cvt_pk_bf16_f32 v35, v150, v151
    v_cvt_pk_bf16_f32 v36, v152, v153
    v_cvt_pk_bf16_f32 v37, v154, v155
    v_cvt_pk_bf16_f32 v38, v156, v157
    v_cvt_pk_bf16_f32 v39, v158, v159
    s_waitcnt lgkmcnt(0)
    ds_read_b128 v[208:211], v19 offset:0
    ds_read_b128 v[212:215], v19 offset:32
    ds_read_b128 v[216:219], v19 offset:64
    ds_read_b128 v[220:223], v19 offset:96
    ds_read_b64_tr_b16 a[240:241], v15 offset:20480
    ds_read_b64_tr_b16 a[242:243], v15 offset:20992
    ds_read_b64_tr_b16 a[244:245], v15 offset:22528
    ds_read_b64_tr_b16 a[246:247], v15 offset:23040
    v_mfma_f32_32x32x16_bf16 v[144:159], a[224:227], v[32:35], 0
    v_cvt_pk_bf16_f32 v40, v160, v161
    v_cvt_pk_bf16_f32 v41, v162, v163
    v_cvt_pk_bf16_f32 v42, v164, v165
    v_cvt_pk_bf16_f32 v43, v166, v167
    v_cvt_pk_bf16_f32 v44, v168, v169
    v_cvt_pk_bf16_f32 v45, v170, v171
    v_cvt_pk_bf16_f32 v46, v172, v173
    v_mfma_f32_32x32x16_bf16 v[176:191], a[228:231], v[32:35], 0
    s_add_u32 m0, s58, 32768
    s_nop 0
    buffer_load_dwordx4 v4, s[12:15], s82 offen  lds
    v_cvt_pk_bf16_f32 v47, v174, v175
    s_waitcnt lgkmcnt(7)
    v_mul_f32 v224, v208, v224
    v_mul_f32 v225, v209, v225
    v_mul_f32 v226, v210, v226
    v_mul_f32 v227, v211, v227
    s_waitcnt lgkmcnt(6)
    v_mul_f32 v228, v212, v228
    v_mfma_f32_32x32x16_bf16 v[160:175], a[232:235], v[32:35], 0
    ds_read_b64_tr_b16 a[248:249], v16 offset:20480
    v_mul_f32 v229, v213, v229
    v_mul_f32 v230, v214, v230
    v_mul_f32 v231, v215, v231
    s_waitcnt lgkmcnt(6)
    v_mul_f32 v232, v216, v232
    v_mul_f32 v233, v217, v233
    v_mul_f32 v234, v218, v234
    v_mfma_f32_32x32x16_bf16 v[192:207], a[236:239], v[32:35], 0
    s_waitcnt lgkmcnt(1)
    buffer_load_dwordx4 v5, s[12:15], s82 offen offset:1024  lds
    v_mul_f32 v235, v219, v235
    v_mul_f32 v236, v220, v236
    v_mul_f32 v237, v221, v237
    v_mul_f32 v238, v222, v238
    v_mul_f32 v239, v223, v239
    v_cvt_pk_bf16_f32 v24, v224, v225
    v_mfma_f32_32x32x16_bf16 v[144:159], a[240:243], v[36:39], v[144:159]
    v_cvt_pk_bf16_f32 v25, v226, v227
    v_cvt_pk_bf16_f32 v26, v228, v229
    v_cvt_pk_bf16_f32 v27, v230, v231
    v_cvt_pk_bf16_f32 v28, v232, v233
    v_cvt_pk_bf16_f32 v29, v234, v235
    v_cvt_pk_bf16_f32 v30, v236, v237
    v_cvt_pk_bf16_f32 v31, v238, v239
    v_mfma_f32_32x32x16_bf16 v[208:223], v[24:27], a[200:203], 0
    ds_read_b64_tr_b16 a[250:251], v16 offset:20992
    ds_read_b64_tr_b16 a[252:253], v16 offset:22528
    ds_read_b64_tr_b16 a[254:255], v16 offset:23040
    v_mfma_f32_32x32x16_bf16 v[224:239], v[24:27], a[208:211], 0
    ds_read_b64_tr_b16 a[224:225], v15 offset:24576
    ds_read_b64_tr_b16 a[226:227], v15 offset:25088
    s_add_u32 m0, s58, 34816
    s_nop 0
    buffer_load_dwordx4 v4, s[16:19], s82 offen  lds
    v_mfma_f32_32x32x16_bf16 v[208:223], v[28:31], a[204:207], v[208:223]
    ds_read_b64_tr_b16 a[228:229], v15 offset:26624
    ds_read_b64_tr_b16 a[230:231], v15 offset:27136
    v_mfma_f32_32x32x16_bf16 v[224:239], v[28:31], a[212:215], v[224:239]
    ds_read_b64_tr_b16 a[232:233], v16 offset:24576
    ds_read_b64_tr_b16 a[234:235], v16 offset:25088
    v_mfma_f32_32x32x16_bf16 v[176:191], a[244:247], v[36:39], v[176:191]
    s_waitcnt lgkmcnt(6)
    ds_read_b64_tr_b16 a[236:237], v16 offset:26624
    ds_read_b64_tr_b16 a[238:239], v16 offset:27136
    buffer_load_dwordx4 v5, s[16:19], s82 offen offset:1024  lds
    v_mfma_f32_32x32x16_bf16 v[160:175], a[248:251], v[36:39], v[160:175]
    ds_read_b64_tr_b16 a[240:241], v15 offset:28672
    ds_read_b64_tr_b16 a[242:243], v15 offset:29184
    s_nop 1
    v_add_f32 v208, v208, v232
    v_sub_f32 v216, v216, v224
    v_add_f32 v209, v209, v233
    v_sub_f32 v217, v217, v225
    v_add_f32 v210, v210, v234
    v_mfma_f32_32x32x16_bf16 v[192:207], a[252:255], v[36:39], v[192:207]
    s_waitcnt lgkmcnt(6)
    ds_read_b64_tr_b16 a[244:245], v15 offset:30720
    ds_read_b64_tr_b16 a[246:247], v15 offset:31232
    v_sub_f32 v218, v218, v226
    v_add_f32 v211, v211, v235
    v_sub_f32 v219, v219, v227
    v_add_f32 v212, v212, v236
    v_mfma_f32_32x32x16_bf16 v[144:159], a[224:227], v[40:43], v[144:159]
    s_add_u32 m0, s58, 49152
    s_nop 0
    buffer_load_dwordx4 v4, s[12:15], s83 offen  lds
    ds_read_b64_tr_b16 a[248:249], v16 offset:28672
    ds_read_b64_tr_b16 a[250:251], v16 offset:29184
    v_sub_f32 v220, v220, v228
    v_add_f32 v213, v213, v237
    v_sub_f32 v221, v221, v229
    v_mfma_f32_32x32x16_bf16 v[176:191], a[228:231], v[40:43], v[176:191]
    s_waitcnt lgkmcnt(6)
    ds_read_b64_tr_b16 a[252:253], v16 offset:30720
    ds_read_b64_tr_b16 a[254:255], v16 offset:31232
    v_add_f32 v214, v214, v238
    v_sub_f32 v222, v222, v230
    v_add_f32 v215, v215, v239
    v_sub_f32 v223, v223, v231
    v_mfma_f32_32x32x16_bf16 v[160:175], a[232:235], v[40:43], v[160:175]
    v_cvt_pk_bf16_f32 v24, v208, v209
    v_cvt_pk_bf16_f32 v26, v216, v217
    v_cvt_pk_bf16_f32 v25, v210, v211
    v_cvt_pk_bf16_f32 v27, v218, v219
    v_mfma_f32_32x32x16_bf16 v[192:207], a[236:239], v[40:43], v[192:207]
    s_waitcnt lgkmcnt(4)
    s_waitcnt vmcnt(8)
    s_waitcnt lgkmcnt(0)
    s_barrier
    buffer_load_dwordx4 v5, s[12:15], s83 offen offset:1024  lds
    v_cvt_pk_bf16_f32 v28, v212, v213
    v_cvt_pk_bf16_f32 v30, v220, v221
    v_cvt_pk_bf16_f32 v29, v214, v215
    v_cvt_pk_bf16_f32 v31, v222, v223
    v_mfma_f32_32x32x16_bf16 v[144:159], a[240:243], v[44:47], v[144:159]
    s_lshl_b32 s4, s50, 17
    s_lshl_b32 s5, s55, 7
    s_add_u32 s4, s4, s5
    s_add_u32 s4, s4, 7340032
    v_permlane32_swap_b32 v24, v26
    v_permlane32_swap_b32 v25, v27
    v_permlane32_swap_b32 v28, v30
    v_permlane32_swap_b32 v29, v31
    v_mfma_f32_32x32x16_bf16 v[208:223], a[216:219], v[48:51], v[240:255]
    ds_read_b64_tr_b16 a[224:225], v11 offset:0
    ds_read_b64_tr_b16 a[226:227], v11 offset:512
    ds_read_b64_tr_b16 a[228:229], v11 offset:2048
    ds_read_b64_tr_b16 a[230:231], v11 offset:2560
    buffer_store_dwordx4 v[24:27], v22, s[36:39], s4 offen offset:0 sc1
    buffer_store_dwordx4 v[28:31], v22, s[36:39], s4 offen offset:64 sc1
    v_mfma_f32_32x32x16_bf16 v[208:223], a[220:223], v[52:55], v[208:223]
    s_add_u32 m0, s58, 51200
    s_nop 0
    buffer_load_dwordx4 v4, s[16:19], s83 offen  lds
    ds_read_b64_tr_b16 a[232:233], v12 offset:0
    ds_read_b64_tr_b16 a[234:235], v12 offset:512
    v_mfma_f32_32x32x16_bf16 v[176:191], a[244:247], v[44:47], v[176:191]
    ds_read_b64_tr_b16 a[236:237], v12 offset:2048
    ds_read_b64_tr_b16 a[238:239], v12 offset:2560
    s_lshl_b32 s70, s50, 10
    s_lshl_b32 s60, s55, 4
    s_add_u32 s70, s70, s60
    s_add_u32 s70, s70, 12713984
    v_mfma_f32_32x32x16_bf16 v[160:175], a[248:251], v[44:47], v[160:175]
    v_cvt_pk_bf16_f32 v48, v208, v209
    v_cvt_pk_bf16_f32 v49, v210, v211
    v_cvt_pk_bf16_f32 v50, v212, v213
    v_cvt_pk_bf16_f32 v51, v214, v215
    v_mfma_f32_32x32x16_bf16 v[192:207], a[252:255], v[44:47], v[192:207]
    s_waitcnt lgkmcnt(4)
    v_cvt_pk_bf16_f32 v52, v216, v217
    v_cvt_pk_bf16_f32 v53, v218, v219
    v_cvt_pk_bf16_f32 v54, v220, v221
    v_cvt_pk_bf16_f32 v55, v222, v223
    v_mfma_f32_32x32x16_bf16 v[144:159], a[224:227], v[48:51], v[144:159]
    buffer_load_dwordx4 v5, s[16:19], s83 offen offset:1024  lds
    ds_read_b64_tr_b16 a[240:241], v11 offset:4096
    ds_read_b64_tr_b16 a[242:243], v11 offset:4608
    v_mfma_f32_32x32x16_bf16 v[176:191], a[228:231], v[48:51], v[176:191]
    ds_read_b64_tr_b16 a[244:245], v11 offset:6144
    ds_read_b64_tr_b16 a[246:247], v11 offset:6656
    s_waitcnt vmcnt(12)
    v_cmp_eq_u32 vcc, 0, v17
    s_nop 0
    s_cbranch_vccnz L_slow_z
L_ok_z:
    s_waitcnt vmcnt(10)
    s_mov_b64 exec, 1
    buffer_store_dword v2, v3, s[36:39], s68 offen sc1
    s_mov_b64 exec, -1
    v_mfma_f32_32x32x16_bf16 v[208:223], a[216:219], v[56:59], v[240:255]
    ds_read_b64_tr_b16 a[248:249], v12 offset:4096
    ds_read_b64_tr_b16 a[250:251], v12 offset:4608
    s_add_u32 m0, s58, 65536
    s_nop 0
    buffer_load_dwordx4 v4, s[12:15], s84 offen  lds
    v_mfma_f32_32x32x16_bf16 v[208:223], a[220:223], v[60:63], v[208:223]
    s_waitcnt lgkmcnt(6)
    ds_read_b64_tr_b16 a[252:253], v12 offset:6144
    ds_read_b64_tr_b16 a[254:255], v12 offset:6656
    v_mfma_f32_32x32x16_bf16 v[160:175], a[232:235], v[48:51], v[160:175]
    ds_read_b64_tr_b16 a[224:225], v11 offset:8192
    ds_read_b64_tr_b16 a[226:227], v11 offset:8704
    v_mfma_f32_32x32x16_bf16 v[192:207], a[236:239], v[48:51], v[192:207]
    s_waitcnt lgkmcnt(6)
    ds_read_b64_tr_b16 a[228:229], v11 offset:10240
    ds_read_b64_tr_b16 a[230:231], v11 offset:10752
    buffer_load_dwordx4 v5, s[12:15], s84 offen offset:1024  lds
    s_nop 0
    v_cvt_pk_bf16_f32 v56, v208, v209
    v_cvt_pk_bf16_f32 v57, v210, v211
    v_mfma_f32_32x32x16_bf16 v[144:159], a[240:243], v[52:55], v[144:159]
    ds_read_b64_tr_b16 a[232:233], v12 offset:8192
    v_cvt_pk_bf16_f32 v58, v212, v213
    v_cvt_pk_bf16_f32 v59, v214, v215
    v_mfma_f32_32x32x16_bf16 v[176:191], a[244:247], v[52:55], v[176:191]
    s_waitcnt lgkmcnt(5)
    v_cvt_pk_bf16_f32 v60, v216, v217
    v_cvt_pk_bf16_f32 v61, v218, v219
    v_mfma_f32_32x32x16_bf16 v[160:175], a[248:251], v[52:55], v[160:175]
    ds_read_b64_tr_b16 a[234:235], v12 offset:8704
    v_cvt_pk_bf16_f32 v62, v220, v221
    v_cvt_pk_bf16_f32 v63, v222, v223
    v_mfma_f32_32x32x16_bf16 v[192:207], a[252:255], v[52:55], v[192:207]
    s_waitcnt lgkmcnt(2)
    ds_read_b64_tr_b16 a[236:237], v12 offset:10240
    ds_read_b64_tr_b16 a[238:239], v12 offset:10752
    s_add_u32 m0, s58, 67584
    s_nop 0
    buffer_load_dwordx4 v4, s[16:19], s84 offen  lds
    v_mfma_f32_32x32x16_bf16 v[144:159], a[224:227], v[56:59], v[144:159]
    ds_read_b64_tr_b16 a[240:241], v11 offset:12288
    ds_read_b64_tr_b16 a[242:243], v11 offset:12800
    v_min_u32 v18, 27, v0
    v_mfma_f32_32x32x16_bf16 v[176:191], a[228:231], v[56:59], v[176:191]
    ds_read_b64_tr_b16 a[244:245], v11 offset:14336
    ds_read_b64_tr_b16 a[246:247], v11 offset:14848
    buffer_load_dwordx4 v5, s[16:19], s84 offen offset:1024  lds
    s_lshl_b32 s4, s48, 9
    v_lshlrev_b32 v18, 4, v18
    v_mfma_f32_32x32x16_bf16 v[208:223], a[216:219], v[64:67], v[240:255]
    ds_read_b64_tr_b16 a[248:249], v12 offset:12288
    ds_read_b64_tr_b16 a[250:251], v12 offset:12800
    s_lshl_b32 s60, s54, 11
    s_add_u32 s4, s4, s60
    s_add_u32 s4, s4, 12730368
    s_lshr_b32 s64, s55, 1
    s_lshl_b32 s64, s64, 9
    v_mfma_f32_32x32x16_bf16 v[208:223], a[220:223], v[68:71], v[208:223]
    s_waitcnt lgkmcnt(6)
    ds_read_b64_tr_b16 a[252:253], v12 offset:14336
    ds_read_b64_tr_b16 a[254:255], v12 offset:14848
    s_and_b32 s60, s50, 1
    s_lshl_b32 s60, s60, 8
    s_add_u32 s64, s64, s60
    s_and_b32 s60, s55, 1
    v_mfma_f32_32x32x16_bf16 v[160:175], a[232:235], v[56:59], v[160:175]
    ds_read_b64_tr_b16 a[224:225], v11 offset:16384
    ds_read_b64_tr_b16 a[226:227], v11 offset:16896
    s_add_u32 m0, s58, 81920
    s_nop 0
    buffer_load_dwordx4 v4, s[12:15], s85 offen  lds
    s_mul_i32 s60, s60, 112
    s_add_u32 s64, s64, s60
    v_mfma_f32_32x32x16_bf16 v[192:207], a[236:239], v[56:59], v[192:207]
    s_waitcnt lgkmcnt(6)
    ds_read_b64_tr_b16 a[228:229], v11 offset:18432
    ds_read_b64_tr_b16 a[230:231], v11 offset:18944
    v_cvt_pk_bf16_f32 v64, v208, v209
    v_mfma_f32_32x32x16_bf16 v[144:159], a[240:243], v[60:63], v[144:159]
    s_lshr_b32 s60, s50, 1
    v_cvt_pk_bf16_f32 v65, v210, v211
    v_cvt_pk_bf16_f32 v66, v212, v213
    v_mfma_f32_32x32x16_bf16 v[176:191], a[244:247], v[60:63], v[176:191]
    s_waitcnt lgkmcnt(4)
    v_cvt_pk_bf16_f32 v67, v214, v215
    v_cvt_pk_bf16_f32 v68, v216, v217
    v_mfma_f32_32x32x16_bf16 v[160:175], a[248:251], v[60:63], v[160:175]
    buffer_load_dwordx4 v5, s[12:15], s85 offen offset:1024  lds
    v_cvt_pk_bf16_f32 v69, v218, v219
    v_cvt_pk_bf16_f32 v70, v220, v221
    v_cvt_pk_bf16_f32 v71, v222, v223
    v_mfma_f32_32x32x16_bf16 v[192:207], a[252:255], v[60:63], v[192:207]
    s_waitcnt lgkmcnt(0)
    ds_read_b64_tr_b16 a[232:233], v12 offset:16384
    ds_read_b64_tr_b16 a[234:235], v12 offset:16896
    ds_read_b64_tr_b16 a[236:237], v12 offset:18432
    ds_read_b64_tr_b16 a[238:239], v12 offset:18944
    v_mfma_f32_32x32x16_bf16 v[144:159], a[224:227], v[64:67], v[144:159]
    ds_read_b64_tr_b16 a[240:241], v11 offset:20480
    ds_read_b64_tr_b16 a[242:243], v11 offset:20992
    v_mfma_f32_32x32x16_bf16 v[176:191], a[228:231], v[64:67], v[176:191]
    ds_read_b64_tr_b16 a[244:245], v11 offset:22528
    ds_read_b64_tr_b16 a[246:247], v11 offset:23040
    s_add_u32 m0, s58, 83968
    s_nop 0
    buffer_load_dwordx4 v4, s[16:19], s85 offen  lds
    s_lshl_b32 s60, s60, 4
    s_add_u32 s64, s64, s60
    s_add_u32 s64, s64, 12648448
    v_mfma_f32_32x32x16_bf16 v[208:223], a[216:219], v[72:75], v[240:255]
    s_waitcnt vmcnt(10)
    s_mov_b64 exec, 1
    buffer_store_dword v2, v3, s[36:39], s70 offen sc1
    s_mov_b64 exec, -1
    ds_read_b64_tr_b16 a[248:249], v12 offset:20480
    v_mfma_f32_32x32x16_bf16 v[208:223], a[220:223], v[76:79], v[208:223]
    s_waitcnt lgkmcnt(5)
    ds_read_b64_tr_b16 a[250:251], v12 offset:20992
    ds_read_b64_tr_b16 a[252:253], v12 offset:22528
    ds_read_b64_tr_b16 a[254:255], v12 offset:23040
    buffer_load_dwordx4 v5, s[16:19], s85 offen offset:1024  lds
    v_mfma_f32_32x32x16_bf16 v[160:175], a[232:235], v[64:67], v[160:175]
    ds_read_b64_tr_b16 a[224:225], v11 offset:24576
    ds_read_b64_tr_b16 a[226:227], v11 offset:25088
    s_and_b32 s60, s48, 1
    s_lshl_b32 s61, s60, 10
    v_mfma_f32_32x32x16_bf16 v[192:207], a[236:239], v[64:67], v[192:207]
    s_waitcnt lgkmcnt(6)
    ds_read_b64_tr_b16 a[228:229], v11 offset:26624
    ds_read_b64_tr_b16 a[230:231], v11 offset:27136
    v_cvt_pk_bf16_f32 v72, v208, v209
    v_mfma_f32_32x32x16_bf16 v[144:159], a[240:243], v[68:71], v[144:159]
    s_add_u32 s79, s79, 128
    s_add_u32 m0, s58, 98304
    s_nop 0
    buffer_load_dwordx4 v4, s[12:15], s79 offen  lds
    v_cvt_pk_bf16_f32 v73, v210, v211
    v_cvt_pk_bf16_f32 v74, v212, v213
    v_mfma_f32_32x32x16_bf16 v[176:191], a[244:247], v[68:71], v[176:191]
    s_waitcnt lgkmcnt(4)
    v_cvt_pk_bf16_f32 v75, v214, v215
    v_cvt_pk_bf16_f32 v76, v216, v217
    v_mfma_f32_32x32x16_bf16 v[160:175], a[248:251], v[68:71], v[160:175]
    v_cvt_pk_bf16_f32 v77, v218, v219
    v_cvt_pk_bf16_f32 v78, v220, v221
    v_cvt_pk_bf16_f32 v79, v222, v223
    v_mfma_f32_32x32x16_bf16 v[192:207], a[252:255], v[68:71], v[192:207]
    s_waitcnt lgkmcnt(0)
    ds_read_b64_tr_b16 a[232:233], v12 offset:24576
    ds_read_b64_tr_b16 a[234:235], v12 offset:25088
    ds_read_b64_tr_b16 a[236:237], v12 offset:26624
    ds_read_b64_tr_b16 a[238:239], v12 offset:27136
    v_mfma_f32_32x32x16_bf16 v[144:159], a[224:227], v[72:75], v[144:159]
    buffer_load_dwordx4 v5, s[12:15], s79 offen offset:1024  lds
    ds_read_b64_tr_b16 a[240:241], v11 offset:28672
    v_mfma_f32_32x32x16_bf16 v[176:191], a[228:231], v[72:75], v[176:191]
    ds_read_b64_tr_b16 a[242:243], v11 offset:29184
    ds_read_b64_tr_b16 a[244:245], v11 offset:30720
    ds_read_b64_tr_b16 a[246:247], v11 offset:31232
    v_mfma_f32_32x32x16_bf16 v[208:223], a[216:219], v[80:83], v[240:255]
    ds_read_b64_tr_b16 a[248:249], v12 offset:28672
    ds_read_b64_tr_b16 a[250:251], v12 offset:29184
    s_add_u32 m0, s58, 100352
    s_nop 0
    buffer_load_dwordx4 v4, s[16:19], s79 offen  lds
    v_mfma_f32_32x32x16_bf16 v[208:223], a[220:223], v[84:87], v[208:223]
    s_waitcnt lgkmcnt(6)
    ds_read_b64_tr_b16 a[252:253], v12 offset:30720
    ds_read_b64_tr_b16 a[254:255], v12 offset:31232
    v_add_u32 v6, s61, v1
    v_mfma_f32_32x32x16_bf16 v[160:175], a[232:235], v[72:75], v[160:175]
    s_lshl_b32 s71, s60, 13
    s_lshr_b32 s61, s48, 1
    s_lshl_b32 s63, s61, 14
    s_add_u32 s71, s71, s63
    v_xor_b32 v7, 0x400, v6
    v_mfma_f32_32x32x16_bf16 v[192:207], a[236:239], v[72:75], v[192:207]
    s_waitcnt lgkmcnt(4)
    s_waitcnt vmcnt(13)
    s_waitcnt lgkmcnt(0)
    s_barrier
    ds_read_b64_tr_b16 a[224:225], v11 offset:32768
    ds_read_b64_tr_b16 a[226:227], v11 offset:33280
    ds_read_b64_tr_b16 a[228:229], v11 offset:34816
    ds_read_b64_tr_b16 a[230:231], v11 offset:35328
    v_mfma_f32_32x32x16_bf16 v[144:159], a[240:243], v[76:79], v[144:159]
    buffer_load_dwordx4 v5, s[16:19], s79 offen offset:1024  lds
    ds_read_b64_tr_b16 a[232:233], v12 offset:32768
    v_cvt_pk_bf16_f32 v80, v208, v209
    v_cvt_pk_bf16_f32 v81, v210, v211
    v_mfma_f32_32x32x16_bf16 v[176:191], a[244:247], v[76:79], v[176:191]
    ds_read_b64_tr_b16 a[234:235], v12 offset:33280
    s_mul_i32 s63, s54, 229376
    v_cvt_pk_bf16_f32 v82, v212, v213
    v_cvt_pk_bf16_f32 v83, v214, v215
    v_mfma_f32_32x32x16_bf16 v[160:175], a[248:251], v[76:79], v[160:175]
    v_cvt_pk_bf16_f32 v84, v216, v217
    v_cvt_pk_bf16_f32 v85, v218, v219
    v_cvt_pk_bf16_f32 v86, v220, v221
    v_cvt_pk_bf16_f32 v87, v222, v223
    v_mfma_f32_32x32x16_bf16 v[192:207], a[252:255], v[76:79], v[192:207]
    s_waitcnt lgkmcnt(2)
    ds_read_b64_tr_b16 a[236:237], v12 offset:34816
    ds_read_b64_tr_b16 a[238:239], v12 offset:35328
    s_add_u32 s80, s80, 128
    s_add_u32 m0, s58, 114688
    s_nop 0
    buffer_load_dwordx4 v4, s[12:15], s80 offen  lds
    v_mfma_f32_32x32x16_bf16 v[144:159], a[224:227], v[80:83], v[144:159]
    ds_read_b64_tr_b16 a[240:241], v11 offset:36864
    ds_read_b64_tr_b16 a[242:243], v11 offset:37376
    s_add_u32 s71, s71, s63
    s_add_u32 s71, s71, 11010048
    v_mfma_f32_32x32x16_bf16 v[176:191], a[228:231], v[80:83], v[176:191]
    ds_read_b64_tr_b16 a[244:245], v11 offset:38912
    ds_read_b64_tr_b16 a[246:247], v11 offset:39424
    buffer_load_dwordx4 v5, s[12:15], s80 offen offset:1024  lds
    v_mfma_f32_32x32x16_bf16 v[208:223], a[216:219], v[88:91], v[240:255]
    ds_read_b64_tr_b16 a[248:249], v12 offset:36864
    ds_read_b64_tr_b16 a[250:251], v12 offset:37376
    v_mfma_f32_32x32x16_bf16 v[208:223], a[220:223], v[92:95], v[208:223]
    s_waitcnt lgkmcnt(6)
    ds_read_b64_tr_b16 a[252:253], v12 offset:38912
    ds_read_b64_tr_b16 a[254:255], v12 offset:39424
    v_mfma_f32_32x32x16_bf16 v[160:175], a[232:235], v[80:83], v[160:175]
    ds_read_b64_tr_b16 a[224:225], v11 offset:40960
    ds_read_b64_tr_b16 a[226:227], v11 offset:41472
    s_add_u32 m0, s58, 116736
    s_nop 0
    buffer_load_dwordx4 v4, s[16:19], s80 offen  lds
    v_mfma_f32_32x32x16_bf16 v[192:207], a[236:239], v[80:83], v[192:207]
    s_waitcnt lgkmcnt(6)
    ds_read_b64_tr_b16 a[228:229], v11 offset:43008
    ds_read_b64_tr_b16 a[230:231], v11 offset:43520
    v_cvt_pk_bf16_f32 v88, v208, v209
    v_cvt_pk_bf16_f32 v89, v210, v211
    v_cvt_pk_bf16_f32 v90, v212, v213
    v_mfma_f32_32x32x16_bf16 v[144:159], a[240:243], v[84:87], v[144:159]
    v_cvt_pk_bf16_f32 v91, v214, v215
    v_cvt_pk_bf16_f32 v92, v216, v217
    v_mfma_f32_32x32x16_bf16 v[176:191], a[244:247], v[84:87], v[176:191]
    s_waitcnt lgkmcnt(4)
    buffer_load_dwordx4 v5, s[16:19], s80 offen offset:1024  lds
    v_cvt_pk_bf16_f32 v93, v218, v219
    v_cvt_pk_bf16_f32 v94, v220, v221
    v_mfma_f32_32x32x16_bf16 v[160:175], a[248:251], v[84:87], v[160:175]
    buffer_load_dword v27, v18, s[36:39], s4 offen sc1
    ds_read_b64_tr_b16 a[232:233], v12 offset:40960
    v_cvt_pk_bf16_f32 v95, v222, v223
    v_mfma_f32_32x32x16_bf16 v[192:207], a[252:255], v[84:87], v[192:207]
    s_waitcnt lgkmcnt(1)
    ds_read_b64_tr_b16 a[234:235], v12 offset:41472
    ds_read_b64_tr_b16 a[236:237], v12 offset:43008
    ds_read_b64_tr_b16 a[238:239], v12 offset:43520
    v_mfma_f32_32x32x16_bf16 v[144:159], a[224:227], v[88:91], v[144:159]
    ds_read_b64_tr_b16 a[240:241], v11 offset:45056
    ds_read_b64_tr_b16 a[242:243], v11 offset:45568
    s_add_u32 s81, s81, 128
    s_add_u32 m0, s58, 131072
    s_nop 0
    buffer_load_dwordx4 v4, s[12:15], s81 offen  lds
    v_mfma_f32_32x32x16_bf16 v[176:191], a[228:231], v[88:91], v[176:191]
    ds_read_b64_tr_b16 a[244:245], v11 offset:47104
    ds_read_b64_tr_b16 a[246:247], v11 offset:47616
    s_lshl_b32 s72, s72, 8
    s_add_u32 s72, s72, s71
    s_lshl_b32 s73, s73, 8
    s_add_u32 s73, s73, s71
    s_lshl_b32 s74, s74, 8
    s_add_u32 s74, s74, s71
    v_mfma_f32_32x32x16_bf16 v[208:223], a[216:219], v[96:99], v[240:255]
    ds_read_b64_tr_b16 a[248:249], v12 offset:45056
    ds_read_b64_tr_b16 a[250:251], v12 offset:45568
    s_lshl_b32 s75, s75, 8
    s_add_u32 s75, s75, s71
    s_lshl_b32 s76, s76, 8
    s_add_u32 s76, s76, s71
    v_mfma_f32_32x32x16_bf16 v[208:223], a[220:223], v[100:103], v[208:223]
    s_waitcnt lgkmcnt(6)
    ds_read_b64_tr_b16 a[252:253], v12 offset:47104
    ds_read_b64_tr_b16 a[254:255], v12 offset:47616
    buffer_load_dwordx4 v5, s[12:15], s81 offen offset:1024  lds
    s_lshl_b32 s77, s77, 8
    v_mfma_f32_32x32x16_bf16 v[160:175], a[232:235], v[88:91], v[160:175]
    ds_read_b64_tr_b16 a[224:225], v11 offset:49152
    ds_read_b64_tr_b16 a[226:227], v11 offset:49664
    s_add_u32 s77, s77, s71
    s_lshl_b32 s78, s78, 8
    s_add_u32 s78, s78, s71
    v_mfma_f32_32x32x16_bf16 v[192:207], a[236:239], v[88:91], v[192:207]
    s_waitcnt lgkmcnt(6)
    ds_read_b64_tr_b16 a[228:229], v11 offset:51200
    ds_read_b64_tr_b16 a[230:231], v11 offset:51712
    v_cvt_pk_bf16_f32 v96, v208, v209
    v_mfma_f32_32x32x16_bf16 v[144:159], a[240:243], v[92:95], v[144:159]
    s_add_u32 m0, s58, 133120
    s_nop 0
    buffer_load_dwordx4 v4, s[16:19], s81 offen  lds
    ds_read_b64_tr_b16 a[232:233], v12 offset:49152
    v_cvt_pk_bf16_f32 v97, v210, v211
    v_mfma_f32_32x32x16_bf16 v[176:191], a[244:247], v[92:95], v[176:191]
    s_waitcnt lgkmcnt(5)
    v_cvt_pk_bf16_f32 v98, v212, v213
    v_cvt_pk_bf16_f32 v99, v214, v215
    v_mfma_f32_32x32x16_bf16 v[160:175], a[248:251], v[92:95], v[160:175]
    v_cvt_pk_bf16_f32 v100, v216, v217
    v_cvt_pk_bf16_f32 v101, v218, v219
    v_cvt_pk_bf16_f32 v102, v220, v221
    v_cvt_pk_bf16_f32 v103, v222, v223
    v_mfma_f32_32x32x16_bf16 v[192:207], a[252:255], v[92:95], v[192:207]
    s_waitcnt lgkmcnt(1)
    ds_read_b64_tr_b16 a[234:235], v12 offset:49664
    ds_read_b64_tr_b16 a[236:237], v12 offset:51200
    ds_read_b64_tr_b16 a[238:239], v12 offset:51712
    v_mfma_f32_32x32x16_bf16 v[144:159], a[224:227], v[96:99], v[144:159]
    buffer_load_dwordx4 v5, s[16:19], s81 offen offset:1024  lds
    v_mfma_f32_32x32x16_bf16 v[176:191], a[228:231], v[96:99], v[176:191]
    ds_read_b64_tr_b16 a[240:241], v11 offset:53248
    ds_read_b64_tr_b16 a[242:243], v11 offset:53760
    ds_read_b64_tr_b16 a[244:245], v11 offset:55296
    ds_read_b64_tr_b16 a[246:247], v11 offset:55808
    v_mfma_f32_32x32x16_bf16 v[208:223], a[216:219], v[104:107], v[240:255]
    ds_read_b64_tr_b16 a[248:249], v12 offset:53248
    ds_read_b64_tr_b16 a[250:251], v12 offset:53760
    s_add_u32 s82, s82, 128
    s_add_u32 m0, s58, 147456
    s_nop 0
    buffer_load_dwordx4 v4, s[12:15], s82 offen  lds
    v_mfma_f32_32x32x16_bf16 v[208:223], a[220:223], v[108:111], v[208:223]
    s_waitcnt lgkmcnt(6)
    ds_read_b64_tr_b16 a[252:253], v12 offset:55296
    ds_read_b64_tr_b16 a[254:255], v12 offset:55808
    v_mfma_f32_32x32x16_bf16 v[160:175], a[232:235], v[96:99], v[160:175]
    ds_read_b64_tr_b16 a[224:225], v11 offset:57344
    ds_read_b64_tr_b16 a[226:227], v11 offset:57856
    v_mfma_f32_32x32x16_bf16 v[192:207], a[236:239], v[96:99], v[192:207]
    s_waitcnt lgkmcnt(6)
    ds_read_b64_tr_b16 a[228:229], v11 offset:59392
    ds_read_b64_tr_b16 a[230:231], v11 offset:59904
    buffer_load_dwordx4 v5, s[12:15], s82 offen offset:1024  lds
    s_nop 0
    v_cvt_pk_bf16_f32 v104, v208, v209
    v_cvt_pk_bf16_f32 v105, v210, v211
    v_cvt_pk_bf16_f32 v106, v212, v213
    v_mfma_f32_32x32x16_bf16 v[144:159], a[240:243], v[100:103], v[144:159]
    v_cvt_pk_bf16_f32 v107, v214, v215
    v_cvt_pk_bf16_f32 v108, v216, v217
    v_cvt_pk_bf16_f32 v109, v218, v219
    v_mfma_f32_32x32x16_bf16 v[176:191], a[244:247], v[100:103], v[176:191]
    s_waitcnt lgkmcnt(4)
    ds_read_b64_tr_b16 a[232:233], v12 offset:57344
    v_cvt_pk_bf16_f32 v110, v220, v221
    v_cvt_pk_bf16_f32 v111, v222, v223
    v_mfma_f32_32x32x16_bf16 v[160:175], a[248:251], v[100:103], v[160:175]
    ds_read_b64_tr_b16 a[234:235], v12 offset:57856
    ds_read_b64_tr_b16 a[236:237], v12 offset:59392
    s_mul_i32 s63, s61, 114688
    v_add_u32 v8, s63, v1
    v_mfma_f32_32x32x16_bf16 v[192:207], a[252:255], v[100:103], v[192:207]
    s_sub_u32 s63, 114688, s63
    s_waitcnt lgkmcnt(3)
    ds_read_b64_tr_b16 a[238:239], v12 offset:59904
    s_waitcnt vmcnt(6)
    v_cmp_eq_u32 vcc, 0, v27
    s_nop 0
    s_cbranch_vccnz L_slow_w
L_ok_w:
    v_and_b32 v18, 15, v0
    v_lshlrev_b32 v18, 4, v18
    v_mfma_f32_32x32x16_bf16 v[144:159], a[224:227], v[104:107], v[144:159]
    s_add_u32 m0, s58, 149504
    s_nop 0
    buffer_load_dwordx4 v4, s[16:19], s82 offen  lds
    ds_read_b64_tr_b16 a[240:241], v11 offset:61440
    ds_read_b64_tr_b16 a[242:243], v11 offset:61952
    v_mfma_f32_32x32x16_bf16 v[176:191], a[228:231], v[104:107], v[176:191]
    ds_read_b64_tr_b16 a[244:245], v11 offset:63488
    ds_read_b64_tr_b16 a[246:247], v11 offset:64000
    buffer_load_dwordx4 a[0:3], v6, s[36:39], s72 offen offset:0 sc1
    s_lshl_b32 s5, s61, 3
    s_add_u32 s5, s5, s60
    s_lshl_b32 s5, s5, 10
    v_add_u32 v9, s63, v1
    v_mfma_f32_32x32x16_bf16 v[208:223], a[216:219], v[112:115], v[240:255]
    s_mul_i32 s63, s53, 229376
    ds_read_b64_tr_b16 a[248:249], v12 offset:61440
    ds_read_b64_tr_b16 a[250:251], v12 offset:61952
    s_add_u32 s5, s5, s63
    s_add_u32 s5, s5, 0
    v_min_u32 v17, 13, v0
    v_mfma_f32_32x32x16_bf16 v[208:223], a[220:223], v[116:119], v[208:223]
    s_waitcnt lgkmcnt(6)
    ds_read_b64_tr_b16 a[252:253], v12 offset:63488
    ds_read_b64_tr_b16 a[254:255], v12 offset:64000
    buffer_load_dwordx4 v5, s[16:19], s82 offen offset:1024  lds
    s_lshl_b32 s65, s53, 9
    s_lshl_b32 s63, s61, 8
    v_lshlrev_b32 v17, 4, v17
    v_mfma_f32_32x32x16_bf16 v[160:175], a[232:235], v[104:107], v[160:175]
    s_add_u32 s65, s65, s63
    s_add_u32 s65, s65, 12648448
    s_mul_i32 s69, s48, 14336
    s_mul_i32 s68, s53, 57344
    s_add_u32 s68, s68, s69
    s_add_u32 s68, s68, 9175040
    s_lshr_b32 s49, s53, 3
    s_lshl_b32 s49, s49, 9
    s_lshl_b32 s63, s60, 8
    s_add_u32 s49, s49, s63
    s_add_u32 s49, s49, 12728320
    v_mfma_f32_32x32x16_bf16 v[192:207], a[236:239], v[104:107], v[192:207]
    s_waitcnt lgkmcnt(4)
    s_waitcnt lgkmcnt(0)
    s_barrier
    ds_read_b64_tr_b16 a[224:225], v13 offset:0
    ds_read_b64_tr_b16 a[226:227], v13 offset:512
    ds_read_b64_tr_b16 a[228:229], v13 offset:2048
    ds_read_b64_tr_b16 a[230:231], v13 offset:2560
    s_lshl_b32 s51, s53, 1
    v_mfma_f32_32x32x16_bf16 v[144:159], a[240:243], v[108:111], v[144:159]
    buffer_load_dwordx4 a[4:7], v7, s[36:39], s72 offen offset:0 sc1
    ds_read_b64_tr_b16 a[232:233], v14 offset:0
    s_add_u32 s51, s51, s61
    v_cvt_pk_bf16_f32 v112, v208, v209
    v_cvt_pk_bf16_f32 v113, v210, v211
    v_mfma_f32_32x32x16_bf16 v[176:191], a[244:247], v[108:111], v[176:191]
    v_cvt_pk_bf16_f32 v114, v212, v213
    v_cvt_pk_bf16_f32 v115, v214, v215
    v_cvt_pk_bf16_f32 v116, v216, v217
    v_mfma_f32_32x32x16_bf16 v[160:175], a[248:251], v[108:111], v[160:175]
    s_add_u32 s83, s83, 128
    s_add_u32 m0, s58, 0
    s_nop 0
    buffer_load_dwordx4 v4, s[12:15], s83 offen  lds
    v_cvt_pk_bf16_f32 v117, v218, v219
    v_cvt_pk_bf16_f32 v118, v220, v221
    v_cvt_pk_bf16_f32 v119, v222, v223
    v_mfma_f32_32x32x16_bf16 v[192:207], a[252:255], v[108:111], v[192:207]
    s_waitcnt lgkmcnt(1)
    ds_read_b64_tr_b16 a[234:235], v14 offset:512
    ds_read_b64_tr_b16 a[236:237], v14 offset:2048
    ds_read_b64_tr_b16 a[238:239], v14 offset:2560
    s_mul_i32 s51, s51, 896
    v_mfma_f32_32x32x16_bf16 v[144:159], a[224:227], v[112:115], v[144:159]
    buffer_load_dwordx4 a[8:11], v6, s[36:39], s73 offen offset:0 sc1
    ds_read_b64_tr_b16 a[240:241], v13 offset:4096
    ds_read_b64_tr_b16 a[242:243], v13 offset:4608
    s_lshl_b32 s63, s54, 7
    s_add_u32 s51, s51, s63
    s_mul_i32 s52, s60, 917504
    s_add_u32 s52, s52, s51
    s_lshl_b32 s63, s60, 6
    s_add_u32 s51, s51, s63
    v_mfma_f32_32x32x16_bf16 v[176:191], a[228:231], v[112:115], v[176:191]
    ds_read_b64_tr_b16 a[244:245], v13 offset:6144
    ds_read_b64_tr_b16 a[246:247], v13 offset:6656
    buffer_load_dwordx4 v5, s[12:15], s83 offen offset:1024  lds
    v_lshrrev_b32 v31, 5, v0
    v_mfma_f32_32x32x16_bf16 v[208:223], a[216:219], v[120:123], v[240:255]
    ds_read_b64_tr_b16 a[248:249], v14 offset:4096
    ds_read_b64_tr_b16 a[250:251], v14 offset:4608
    v_and_b32 v22, 31, v0
    v_lshlrev_b32 v25, 7, v22
    v_mfma_f32_32x32x16_bf16 v[208:223], a[220:223], v[124:127], v[208:223]
    s_waitcnt lgkmcnt(6)
    ds_read_b64_tr_b16 a[252:253], v14 offset:6144
    ds_read_b64_tr_b16 a[254:255], v14 offset:6656
    buffer_load_dwordx4 a[12:15], v7, s[36:39], s73 offen offset:0 sc1
    v_mul_u32_u24 v22, 57344, v22
    v_mfma_f32_32x32x16_bf16 v[160:175], a[232:235], v[112:115], v[160:175]
    ds_read_b64_tr_b16 a[224:225], v13 offset:8192
    ds_read_b64_tr_b16 a[226:227], v13 offset:8704
    s_lshl_b32 s63, s61, 12
    v_lshl_add_u32 v22, v31, 4, v22
    v_add_u32 v25, s63, v25
    v_mfma_f32_32x32x16_bf16 v[192:207], a[236:239], v[112:115], v[192:207]
    s_waitcnt lgkmcnt(6)
    ds_read_b64_tr_b16 a[228:229], v13 offset:10240
    ds_read_b64_tr_b16 a[230:231], v13 offset:10752
    s_add_u32 m0, s58, 2048
    s_nop 0
    buffer_load_dwordx4 v4, s[16:19], s83 offen  lds
    v_cvt_pk_bf16_f32 v120, v208, v209
    v_mfma_f32_32x32x16_bf16 v[144:159], a[240:243], v[116:119], v[144:159]
    ds_read_b64_tr_b16 a[232:233], v14 offset:8192
    s_lshl_b32 s63, s60, 2
    v_cvt_pk_bf16_f32 v121, v210, v211
    v_cvt_pk_bf16_f32 v122, v212, v213
    v_mfma_f32_32x32x16_bf16 v[176:191], a[244:247], v[116:119], v[176:191]
    s_waitcnt lgkmcnt(5)
    buffer_load_dwordx4 a[16:19], v6, s[36:39], s74 offen offset:0 sc1
    v_cvt_pk_bf16_f32 v123, v214, v215
    v_cvt_pk_bf16_f32 v124, v216, v217
    v_mfma_f32_32x32x16_bf16 v[160:175], a[248:251], v[116:119], v[160:175]
    v_cvt_pk_bf16_f32 v125, v218, v219
    v_cvt_pk_bf16_f32 v126, v220, v221
    v_cvt_pk_bf16_f32 v127, v222, v223
    v_mfma_f32_32x32x16_bf16 v[192:207], a[252:255], v[116:119], v[192:207]
    s_waitcnt lgkmcnt(1)
    ds_read_b64_tr_b16 a[234:235], v14 offset:8704
    ds_read_b64_tr_b16 a[236:237], v14 offset:10240
    ds_read_b64_tr_b16 a[238:239], v14 offset:10752
    buffer_load_dwordx4 v5, s[16:19], s83 offen offset:1024  lds
    v_mfma_f32_32x32x16_bf16 v[144:159], a[224:227], v[120:123], v[144:159]
    ds_read_b64_tr_b16 a[240:241], v13 offset:12288
    ds_read_b64_tr_b16 a[242:243], v13 offset:12800
    v_xor_b32 v24, s63, v31
    v_bfe_u32 v23, v0, 1, 3
    v_mfma_f32_32x32x16_bf16 v[176:191], a[228:231], v[120:123], v[176:191]
    ds_read_b64_tr_b16 a[244:245], v13 offset:14336
    ds_read_b64_tr_b16 a[246:247], v13 offset:14848
    buffer_load_dwordx4 a[20:23], v7, s[36:39], s74 offen offset:0 sc1
    v_xor_b32 v24, v24, v23
    v_lshl_add_u32 v25, v24, 4, v25
    v_mfma_f32_32x32x16_bf16 v[208:223], a[216:219], v[128:131], v[240:255]
    ds_read_b64_tr_b16 a[248:249], v14 offset:12288
    ds_read_b64_tr_b16 a[250:251], v14 offset:12800
    v_lshrrev_b32 v24, 4, v0
    v_and_b32 v23, 7, v0
    v_mfma_f32_32x32x16_bf16 v[208:223], a[220:223], v[132:135], v[208:223]
    s_waitcnt lgkmcnt(6)
    ds_read_b64_tr_b16 a[252:253], v14 offset:14336
    ds_read_b64_tr_b16 a[254:255], v14 offset:14848
    s_add_u32 s84, s84, 128
    s_add_u32 m0, s58, 16384
    s_nop 0
    buffer_load_dwordx4 v4, s[12:15], s84 offen  lds
    v_mfma_f32_32x32x16_bf16 v[160:175], a[232:235], v[120:123], v[160:175]
    ds_read_b64_tr_b16 a[224:225], v13 offset:16384
    ds_read_b64_tr_b16 a[226:227], v13 offset:16896
    v_xor_b32 v23, v23, v24
    v_lshrrev_b32 v24, 3, v0
    v_mfma_f32_32x32x16_bf16 v[192:207], a[236:239], v[120:123], v[192:207]
    s_waitcnt lgkmcnt(6)
    ds_read_b64_tr_b16 a[228:229], v13 offset:18432
    ds_read_b64_tr_b16 a[230:231], v13 offset:18944
    buffer_load_dwordx4 a[24:27], v6, s[36:39], s75 offen offset:0 sc1
    v_cvt_pk_bf16_f32 v128, v208, v209
    v_mfma_f32_32x32x16_bf16 v[144:159], a[240:243], v[124:127], v[144:159]
    ds_read_b64_tr_b16 a[232:233], v14 offset:16384
    v_cvt_pk_bf16_f32 v129, v210, v211
    v_cvt_pk_bf16_f32 v130, v212, v213
    v_cvt_pk_bf16_f32 v131, v214, v215
    v_mfma_f32_32x32x16_bf16 v[176:191], a[244:247], v[124:127], v[176:191]
    s_waitcnt lgkmcnt(5)
    buffer_load_dwordx4 v5, s[12:15], s84 offen offset:1024  lds
    v_cvt_pk_bf16_f32 v132, v216, v217
    v_cvt_pk_bf16_f32 v133, v218, v219
    v_mfma_f32_32x32x16_bf16 v[160:175], a[248:251], v[124:127], v[160:175]
    ds_read_b64_tr_b16 a[234:235], v14 offset:16896
    ds_read_b64_tr_b16 a[236:237], v14 offset:18432
    v_cvt_pk_bf16_f32 v134, v220, v221
    v_cvt_pk_bf16_f32 v135, v222, v223
    v_mfma_f32_32x32x16_bf16 v[192:207], a[252:255], v[124:127], v[192:207]
    s_waitcnt lgkmcnt(3)
    ds_read_b64_tr_b16 a[238:239], v14 offset:18944
    buffer_load_dwordx4 a[28:31], v7, s[36:39], s75 offen offset:0 sc1
    ds_read_b64_tr_b16 a[240:241], v13 offset:20480
    v_mul_u32_u24 v24, 57344, v24
    v_mfma_f32_32x32x16_bf16 v[144:159], a[224:227], v[128:131], v[144:159]
    ds_read_b64_tr_b16 a[242:243], v13 offset:20992
    ds_read_b64_tr_b16 a[244:245], v13 offset:22528
    s_mul_i32 s63, s60, 28672
    s_add_u32 s63, s63, 106496
    v_lshl_add_u32 v24, v23, 4, v24
    v_mfma_f32_32x32x16_bf16 v[176:191], a[228:231], v[128:131], v[176:191]
    ds_read_b64_tr_b16 a[246:247], v13 offset:23040
    s_add_u32 m0, s58, 18432
    s_nop 0
    buffer_load_dwordx4 v4, s[16:19], s84 offen  lds
    ds_read_b64_tr_b16 a[248:249], v14 offset:20480
    v_add_u32 v10, s63, v1
    v_mfma_f32_32x32x16_bf16 v[208:223], a[216:219], v[136:139], v[240:255]
    s_mul_i32 s63, s61, 14336
    ds_read_b64_tr_b16 a[250:251], v14 offset:20992
    ds_read_b64_tr_b16 a[252:253], v14 offset:22528
    v_add_u32 v26, s63, v10
    v_bfe_u32 v19, v0, 1, 4
    v_mfma_f32_32x32x16_bf16 v[208:223], a[220:223], v[140:143], v[208:223]
    s_waitcnt lgkmcnt(7)
    ds_read_b64_tr_b16 a[254:255], v14 offset:23040
    buffer_load_dwordx4 a[32:35], v6, s[36:39], s76 offen offset:0 sc1
    ds_read_b64_tr_b16 a[224:225], v13 offset:24576
    v_lshlrev_b32 v23, 7, v19
    v_mfma_f32_32x32x16_bf16 v[160:175], a[232:235], v[128:131], v[160:175]
    ds_read_b64_tr_b16 a[226:227], v13 offset:25088
    ds_read_b64_tr_b16 a[228:229], v13 offset:26624
    v_bfe_u32 v19, v0, 2, 2
    v_xor_b32 v19, v19, v31
    v_mfma_f32_32x32x16_bf16 v[192:207], a[236:239], v[128:131], v[192:207]
    s_waitcnt lgkmcnt(7)
    ds_read_b64_tr_b16 a[230:231], v13 offset:27136
    buffer_load_dwordx4 v5, s[16:19], s84 offen offset:1024  lds
    ds_read_b64_tr_b16 a[232:233], v14 offset:24576
    v_cvt_pk_bf16_f32 v136, v208, v209
    v_mfma_f32_32x32x16_bf16 v[144:159], a[240:243], v[132:135], v[144:159]
    ds_read_b64_tr_b16 a[234:235], v14 offset:25088
    ds_read_b64_tr_b16 a[236:237], v14 offset:26624
    v_cvt_pk_bf16_f32 v137, v210, v211
    v_cvt_pk_bf16_f32 v138, v212, v213
    v_mfma_f32_32x32x16_bf16 v[176:191], a[244:247], v[132:135], v[176:191]
    s_waitcnt lgkmcnt(7)
    ds_read_b64_tr_b16 a[238:239], v14 offset:27136
    buffer_load_dwordx4 a[36:39], v7, s[36:39], s76 offen offset:0 sc1
    v_cvt_pk_bf16_f32 v139, v214, v215
    v_cvt_pk_bf16_f32 v140, v216, v217
    v_mfma_f32_32x32x16_bf16 v[160:175], a[248:251], v[132:135], v[160:175]
    v_cvt_pk_bf16_f32 v141, v218, v219
    v_cvt_pk_bf16_f32 v142, v220, v221
    v_cvt_pk_bf16_f32 v143, v222, v223
    v_mfma_f32_32x32x16_bf16 v[192:207], a[252:255], v[132:135], v[192:207]
    s_waitcnt lgkmcnt(4)
    ds_read_b64_tr_b16 a[240:241], v13 offset:28672
    ds_read_b64_tr_b16 a[242:243], v13 offset:29184
    ds_read_b64_tr_b16 a[244:245], v13 offset:30720
    ds_read_b64_tr_b16 a[246:247], v13 offset:31232
    v_mfma_f32_32x32x16_bf16 v[144:159], a[224:227], v[136:139], v[144:159]
    s_add_u32 s85, s85, 128
    s_add_u32 m0, s58, 32768
    s_nop 0
    buffer_load_dwordx4 v4, s[12:15], s85 offen  lds
    ds_read_b64_tr_b16 a[248:249], v14 offset:28672
    ds_read_b64_tr_b16 a[250:251], v14 offset:29184
    v_lshl_add_u32 v23, v19, 5, v23
    v_mfma_f32_32x32x16_bf16 v[176:191], a[228:231], v[136:139], v[176:191]
    s_waitcnt lgkmcnt(6)
    ds_read_b64_tr_b16 a[252:253], v14 offset:30720
    ds_read_b64_tr_b16 a[254:255], v14 offset:31232
    s_waitcnt vmcnt(18)
    s_barrier
    buffer_load_dwordx4 a[40:43], v6, s[36:39], s77 offen offset:0 sc1
    v_and_b32 v19, 1, v0
    v_mfma_f32_32x32x16_bf16 v[160:175], a[232:235], v[136:139], v[160:175]
    ds_read_b64_tr_b16 a[224:225], v13 offset:32768
    ds_read_b64_tr_b16 a[226:227], v13 offset:33280
    s_mul_i32 s63, s61, 28672
    s_add_u32 s63, s63, 49152
    v_lshl_add_u32 v23, v19, 4, v23
    v_mfma_f32_32x32x16_bf16 v[192:207], a[236:239], v[136:139], v[192:207]
    s_waitcnt lgkmcnt(6)
    ds_read_b64_tr_b16 a[228:229], v13 offset:34816
    ds_read_b64_tr_b16 a[230:231], v13 offset:35328
    buffer_load_dwordx4 v5, s[12:15], s85 offen offset:1024  lds
    v_add_u32 v23, s63, v23
    v_mfma_f32_32x32x16_bf16 v[144:159], a[240:243], v[140:143], v[144:159]
    ds_read_b64_tr_b16 a[232:233], v13 offset:36864
    ds_read_b64_tr_b16 a[234:235], v13 offset:37376
    s_xor_b32 s63, s48, 1
    s_mul_i32 s63, s63, 12288
    s_add_u32 s63, s63, 0
    v_xor_b32 v19, 64, v23
    v_add_u32 v28, s63, v1
    v_mfma_f32_32x32x16_bf16 v[176:191], a[244:247], v[140:143], v[176:191]
    s_waitcnt lgkmcnt(6)
    ds_read_b64_tr_b16 a[236:237], v13 offset:38912
    ds_read_b64_tr_b16 a[238:239], v13 offset:39424
    buffer_load_dwordx4 a[44:47], v7, s[36:39], s77 offen offset:0 sc1
    s_xor_b32 s63, s48, 2
    s_mul_i32 s63, s63, 12288
    s_add_u32 s63, s63, 4096
    v_mfma_f32_32x32x16_bf16 v[160:175], a[248:251], v[140:143], v[160:175]
    ds_read_b64_tr_b16 a[240:241], v13 offset:40960
    ds_read_b64_tr_b16 a[242:243], v13 offset:41472
    v_add_u32 v29, s63, v1
    v_mfma_f32_32x32x16_bf16 v[192:207], a[252:255], v[140:143], v[192:207]
    s_xor_b32 s63, s48, 3
    s_mul_i32 s63, s63, 12288
    s_add_u32 s63, s63, 8192
    s_waitcnt lgkmcnt(6)
    ds_read_b64_tr_b16 a[244:245], v13 offset:43008
    ds_read_b64_tr_b16 a[246:247], v13 offset:43520
    s_add_u32 m0, s58, 34816
    s_nop 0
    buffer_load_dwordx4 v4, s[16:19], s85 offen  lds
    v_add_u32 v30, s63, v1
    v_mfma_f32_32x32x16_bf16 v[208:223], a[224:227], v[32:35], 0
    s_mul_i32 s63, s48, 12288
    s_add_u32 s63, s63, 0
    ds_read_b64_tr_b16 a[248:249], v13 offset:45056
    ds_read_b64_tr_b16 a[250:251], v13 offset:45568
    v_add_u32 v31, s63, v1
    v_mfma_f32_32x32x16_bf16 v[224:239], a[228:231], v[32:35], 0
    s_waitcnt lgkmcnt(6)
    ds_read_b64_tr_b16 a[252:253], v13 offset:47104
    ds_read_b64_tr_b16 a[254:255], v13 offset:47616
    buffer_load_dwordx4 a[48:51], v6, s[36:39], s78 offen offset:0 sc1
    v_mul_f32 v176, v144, v176
    v_mul_f32 v177, v145, v177
    v_mul_f32 v178, v146, v178
    v_mul_f32 v179, v147, v179
    v_mul_f32 v144, v20, v144
    v_mul_f32 v145, v20, v145
    v_mfma_f32_32x32x16_bf16 v[208:223], a[232:235], v[36:39], v[208:223]
    ds_read_b64_tr_b16 a[224:225], v13 offset:49152
    ds_read_b64_tr_b16 a[226:227], v13 offset:49664
    v_mul_f32 v146, v20, v146
    v_mul_f32 v147, v20, v147
    v_exp_f32 v144, v144
    v_exp_f32 v145, v145
    v_mfma_f32_32x32x16_bf16 v[224:239], a[236:239], v[36:39], v[224:239]
    s_waitcnt lgkmcnt(6)
    ds_read_b64_tr_b16 a[228:229], v13 offset:51200
    ds_read_b64_tr_b16 a[230:231], v13 offset:51712
    buffer_load_dwordx4 v5, s[16:19], s85 offen offset:1024  lds
    v_exp_f32 v146, v146
    v_exp_f32 v147, v147
    v_fma_f32 v144, v144, v21, v21
    v_fma_f32 v145, v145, v21, v21
    v_mfma_f32_32x32x16_bf16 v[208:223], a[240:243], v[40:43], v[208:223]
    ds_read_b64_tr_b16 a[232:233], v13 offset:53248
    ds_read_b64_tr_b16 a[234:235], v13 offset:53760
    v_fma_f32 v146, v146, v21, v21
    v_fma_f32 v147, v147, v21, v21
    v_rcp_f32 v144, v144
    v_rcp_f32 v145, v145
    v_mfma_f32_32x32x16_bf16 v[224:239], a[244:247], v[40:43], v[224:239]
    s_waitcnt lgkmcnt(6)
    ds_read_b64_tr_b16 a[236:237], v13 offset:55296
    ds_read_b64_tr_b16 a[238:239], v13 offset:55808
    buffer_load_dwordx4 a[52:55], v7, s[36:39], s78 offen offset:0 sc1
    v_rcp_f32 v146, v146
    v_rcp_f32 v147, v147
    v_mul_f32 v176, v144, v176
    v_mul_f32 v177, v145, v177
    v_mul_f32 v178, v146, v178
    v_mfma_f32_32x32x16_bf16 v[208:223], a[248:251], v[44:47], v[208:223]
    ds_read_b64_tr_b16 a[240:241], v13 offset:57344
    ds_read_b64_tr_b16 a[242:243], v13 offset:57856
    v_mul_f32 v179, v147, v179
    v_cvt_pk_bf16_f32 v144, v176, v177
    v_cvt_pk_bf16_f32 v145, v178, v179
    v_mul_f32 v180, v148, v180
    v_mul_f32 v181, v149, v181
    v_mul_f32 v182, v150, v182
    v_mfma_f32_32x32x16_bf16 v[224:239], a[252:255], v[44:47], v[224:239]
    s_waitcnt lgkmcnt(6)
    ds_read_b64_tr_b16 a[244:245], v13 offset:59392
    ds_read_b64_tr_b16 a[246:247], v13 offset:59904
    buffer_load_dwordx4 a[56:59], v6, s[36:39], s72 offen offset:2048 sc1
    v_mul_f32 v183, v151, v183
    v_mul_f32 v148, v20, v148
    v_mul_f32 v149, v20, v149
    v_mul_f32 v150, v20, v150
    v_mul_f32 v151, v20, v151
    v_mfma_f32_32x32x16_bf16 v[208:223], a[224:227], v[48:51], v[208:223]
    ds_read_b64_tr_b16 a[248:249], v13 offset:61440
    ds_read_b64_tr_b16 a[250:251], v13 offset:61952
    v_exp_f32 v148, v148
    v_exp_f32 v149, v149
    v_exp_f32 v150, v150
    v_mfma_f32_32x32x16_bf16 v[224:239], a[228:231], v[48:51], v[224:239]
    s_waitcnt lgkmcnt(6)
    ds_read_b64_tr_b16 a[252:253], v13 offset:63488
    ds_read_b64_tr_b16 a[254:255], v13 offset:64000
    buffer_load_dwordx4 a[60:63], v7, s[36:39], s72 offen offset:2048 sc1
    v_exp_f32 v151, v151
    v_fma_f32 v148, v148, v21, v21
    v_fma_f32 v149, v149, v21, v21
    v_fma_f32 v150, v150, v21, v21
    v_fma_f32 v151, v151, v21, v21
    v_mfma_f32_32x32x16_bf16 v[208:223], a[232:235], v[52:55], v[208:223]
    ds_read_b64_tr_b16 a[224:225], v15 offset:0
    ds_read_b64_tr_b16 a[226:227], v15 offset:512
    v_rcp_f32 v148, v148
    v_rcp_f32 v149, v149
    v_rcp_f32 v150, v150
    v_rcp_f32 v151, v151
    v_mfma_f32_32x32x16_bf16 v[224:239], a[236:239], v[52:55], v[224:239]
    s_waitcnt lgkmcnt(6)
    ds_read_b64_tr_b16 a[228:229], v15 offset:2048
    ds_read_b64_tr_b16 a[230:231], v15 offset:2560
    buffer_load_dwordx4 a[64:67], v6, s[36:39], s73 offen offset:2048 sc1
    v_mul_f32 v180, v148, v180
    v_mul_f32 v181, v149, v181
    v_mul_f32 v182, v150, v182
    v_mul_f32 v183, v151, v183
    v_cvt_pk_bf16_f32 v146, v180, v181
    v_mfma_f32_32x32x16_bf16 v[208:223], a[240:243], v[56:59], v[208:223]
    ds_read_b64_tr_b16 a[232:233], v15 offset:4096
    ds_read_b64_tr_b16 a[234:235], v15 offset:4608
    v_cvt_pk_bf16_f32 v147, v182, v183
    v_mul_f32 v184, v152, v184
    v_mul_f32 v185, v153, v185
    v_mul_f32 v186, v154, v186
    v_mul_f32 v187, v155, v187
    v_mul_f32 v152, v20, v152
    v_mfma_f32_32x32x16_bf16 v[224:239], a[244:247], v[56:59], v[224:239]
    buffer_store_dwordx4 v[144:147], v1, s[36:39], s66 offen offset:0 sc1
    s_waitcnt lgkmcnt(6)
    ds_read_b64_tr_b16 a[236:237], v15 offset:6144
    ds_read_b64_tr_b16 a[238:239], v15 offset:6656
    buffer_load_dwordx4 a[68:71], v7, s[36:39], s73 offen offset:2048 sc1
    v_mul_f32 v153, v20, v153
    v_mul_f32 v154, v20, v154
    v_mul_f32 v155, v20, v155
    v_exp_f32 v152, v152
    v_mfma_f32_32x32x16_bf16 v[208:223], a[248:251], v[60:63], v[208:223]
    ds_read_b64_tr_b16 a[240:241], v15 offset:8192
    ds_read_b64_tr_b16 a[242:243], v15 offset:8704
    v_exp_f32 v153, v153
    v_exp_f32 v154, v154
    v_exp_f32 v155, v155
    v_fma_f32 v152, v152, v21, v21
    v_fma_f32 v153, v153, v21, v21
    v_mfma_f32_32x32x16_bf16 v[224:239], a[252:255], v[60:63], v[224:239]
    s_waitcnt lgkmcnt(6)
    ds_read_b64_tr_b16 a[244:245], v15 offset:10240
    ds_read_b64_tr_b16 a[246:247], v15 offset:10752
    v_fma_f32 v154, v154, v21, v21
    v_fma_f32 v155, v155, v21, v21
    v_rcp_f32 v152, v152
    v_rcp_f32 v153, v153
    v_mfma_f32_32x32x16_bf16 v[208:223], a[224:227], v[64:67], v[208:223]
    ds_read_b64_tr_b16 a[248:249], v15 offset:12288
    ds_read_b64_tr_b16 a[250:251], v15 offset:12800
    buffer_load_dwordx4 a[72:75], v6, s[36:39], s74 offen offset:2048 sc1
    v_rcp_f32 v154, v154
    v_rcp_f32 v155, v155
    v_mul_f32 v184, v152, v184
    v_mul_f32 v185, v153, v185
    v_mfma_f32_32x32x16_bf16 v[224:239], a[228:231], v[64:67], v[224:239]
    s_waitcnt lgkmcnt(6)
    ds_read_b64_tr_b16 a[252:253], v15 offset:14336
    ds_read_b64_tr_b16 a[254:255], v15 offset:14848
    v_mul_f32 v186, v154, v186
    v_mul_f32 v187, v155, v187
    v_cvt_pk_bf16_f32 v152, v184, v185
    v_cvt_pk_bf16_f32 v153, v186, v187
    v_mul_f32 v188, v156, v188
    v_mul_f32 v189, v157, v189
    v_mfma_f32_32x32x16_bf16 v[208:223], a[232:235], v[68:71], v[208:223]
    ds_read_b64_tr_b16 a[224:225], v15 offset:16384
    ds_read_b64_tr_b16 a[226:227], v15 offset:16896
    buffer_load_dwordx4 a[76:79], v7, s[36:39], s74 offen offset:2048 sc1
    s_lshr_b32 s63, s71, 1
    s_sub_u32 s5, s5, s63
    v_mul_f32 v190, v158, v190
    v_mul_f32 v191, v159, v191
    v_mul_f32 v156, v20, v156
    v_mul_f32 v157, v20, v157
    v_mul_f32 v158, v20, v158
    v_mul_f32 v159, v20, v159
    v_mfma_f32_32x32x16_bf16 v[224:239], a[236:239], v[68:71], v[224:239]
    s_waitcnt lgkmcnt(6)
    ds_read_b64_tr_b16 a[228:229], v15 offset:18432
    ds_read_b64_tr_b16 a[230:231], v15 offset:18944
    s_lshr_b32 s79, s72, 1
    v_exp_f32 v156, v156
    v_exp_f32 v157, v157
    v_exp_f32 v158, v158
    v_mfma_f32_32x32x16_bf16 v[208:223], a[240:243], v[72:75], v[208:223]
    ds_read_b64_tr_b16 a[232:233], v15 offset:20480
    ds_read_b64_tr_b16 a[234:235], v15 offset:20992
    buffer_load_dwordx4 a[80:83], v6, s[36:39], s75 offen offset:2048 sc1
    v_exp_f32 v159, v159
    v_fma_f32 v156, v156, v21, v21
    v_fma_f32 v157, v157, v21, v21
    v_fma_f32 v158, v158, v21, v21
    v_fma_f32 v159, v159, v21, v21
    v_mfma_f32_32x32x16_bf16 v[224:239], a[244:247], v[72:75], v[224:239]
    s_waitcnt lgkmcnt(6)
    ds_read_b64_tr_b16 a[236:237], v15 offset:22528
    ds_read_b64_tr_b16 a[238:239], v15 offset:23040
    s_add_u32 s79, s79, s5
    v_rcp_f32 v156, v156
    v_rcp_f32 v157, v157
    v_rcp_f32 v158, v158
    v_mfma_f32_32x32x16_bf16 v[208:223], a[248:251], v[76:79], v[208:223]
    v_rcp_f32 v159, v159
    v_mul_f32 v188, v156, v188
    v_mul_f32 v189, v157, v189
    v_mul_f32 v190, v158, v190
    v_mul_f32 v191, v159, v191
    v_cvt_pk_bf16_f32 v154, v188, v189
    v_cvt_pk_bf16_f32 v155, v190, v191
    v_mfma_f32_32x32x16_bf16 v[224:239], a[252:255], v[76:79], v[224:239]
    buffer_store_dwordx4 v[152:155], v1, s[36:39], s66 offen offset:1024 sc1
    s_waitcnt lgkmcnt(4)
    ds_read_b64_tr_b16 a[240:241], v15 offset:24576
    ds_read_b64_tr_b16 a[242:243], v15 offset:25088
    ds_read_b64_tr_b16 a[244:245], v15 offset:26624
    ds_read_b64_tr_b16 a[246:247], v15 offset:27136
    buffer_load_dwordx4 a[84:87], v7, s[36:39], s75 offen offset:2048 sc1
    s_lshr_b32 s80, s73, 1
    s_add_u32 s80, s80, s5
    s_lshr_b32 s81, s74, 1
    s_add_u32 s81, s81, s5
    s_lshr_b32 s82, s75, 1
    s_add_u32 s82, s82, s5
    s_lshr_b32 s83, s76, 1
    v_mfma_f32_32x32x16_bf16 v[208:223], a[224:227], v[80:83], v[208:223]
    ds_read_b64_tr_b16 a[248:249], v15 offset:28672
    ds_read_b64_tr_b16 a[250:251], v15 offset:29184
    s_add_u32 s83, s83, s5
    s_lshr_b32 s84, s77, 1
    s_add_u32 s84, s84, s5
    s_lshr_b32 s85, s78, 1
    s_add_u32 s85, s85, s5
    v_mul_f32 v192, v160, v192
    v_mul_f32 v193, v161, v193
    v_mul_f32 v194, v162, v194
    v_mfma_f32_32x32x16_bf16 v[224:239], a[228:231], v[80:83], v[224:239]
    s_waitcnt lgkmcnt(6)
    ds_read_b64_tr_b16 a[252:253], v15 offset:30720
    ds_read_b64_tr_b16 a[254:255], v15 offset:31232
    s_waitcnt vmcnt(11)
    s_barrier
    buffer_load_dwordx4 a[88:91], v6, s[36:39], s76 offen offset:2048 sc1
    v_mul_f32 v195, v163, v195
    v_mul_f32 v160, v20, v160
    v_mul_f32 v161, v20, v161
    v_mfma_f32_32x32x16_bf16 v[208:223], a[232:235], v[84:87], v[208:223]
    ds_read_b64_tr_b16 a[224:225], v11 offset:0
    ds_read_b64_tr_b16 a[226:227], v11 offset:512
    v_mul_f32 v162, v20, v162
    v_mul_f32 v163, v20, v163
    v_exp_f32 v160, v160
    v_mfma_f32_32x32x16_bf16 v[224:239], a[236:239], v[84:87], v[224:239]
    s_waitcnt lgkmcnt(6)
    ds_read_b64_tr_b16 a[228:229], v11 offset:2048
    ds_read_b64_tr_b16 a[230:231], v11 offset:2560
    buffer_load_dwordx4 a[92:95], v7, s[36:39], s76 offen offset:2048 sc1
    v_exp_f32 v161, v161
    v_exp_f32 v162, v162
    v_mfma_f32_32x32x16_bf16 v[208:223], a[240:243], v[88:91], v[208:223]
    ds_read_b64_tr_b16 a[232:233], v11 offset:4096
    ds_read_b64_tr_b16 a[234:235], v11 offset:4608
    v_exp_f32 v163, v163
    v_fma_f32 v160, v160, v21, v21
    v_fma_f32 v161, v161, v21, v21
    v_fma_f32 v162, v162, v21, v21
    v_mfma_f32_32x32x16_bf16 v[224:239], a[244:247], v[88:91], v[224:239]
    s_waitcnt lgkmcnt(6)
    ds_read_b64_tr_b16 a[236:237], v11 offset:6144
    ds_read_b64_tr_b16 a[238:239], v11 offset:6656
    v_fma_f32 v163, v163, v21, v21
    v_rcp_f32 v160, v160
    v_rcp_f32 v161, v161
    v_mfma_f32_32x32x16_bf16 v[208:223], a[248:251], v[92:95], v[208:223]
    ds_read_b64_tr_b16 a[240:241], v11 offset:8192
    ds_read_b64_tr_b16 a[242:243], v11 offset:8704
    buffer_load_dwordx4 a[96:99], v6, s[36:39], s77 offen offset:2048 sc1
    v_rcp_f32 v162, v162
    v_rcp_f32 v163, v163
    v_mfma_f32_32x32x16_bf16 v[224:239], a[252:255], v[92:95], v[224:239]
    s_waitcnt lgkmcnt(6)
    ds_read_b64_tr_b16 a[244:245], v11 offset:10240
    ds_read_b64_tr_b16 a[246:247], v11 offset:10752
    v_mul_f32 v192, v160, v192
    v_mul_f32 v193, v161, v193
    v_mul_f32 v194, v162, v194
    v_mul_f32 v195, v163, v195
    v_mfma_f32_32x32x16_bf16 v[208:223], a[224:227], v[96:99], v[208:223]
    ds_read_b64_tr_b16 a[248:249], v11 offset:12288
    ds_read_b64_tr_b16 a[250:251], v11 offset:12800
    buffer_load_dwordx4 a[100:103], v7, s[36:39], s77 offen offset:2048 sc1
    v_cvt_pk_bf16_f32 v160, v192, v193
    v_cvt_pk_bf16_f32 v161, v194, v195
    v_mul_f32 v196, v164, v196
    v_mul_f32 v197, v165, v197
    v_mfma_f32_32x32x16_bf16 v[224:239], a[228:231], v[96:99], v[224:239]
    s_waitcnt lgkmcnt(6)
    ds_read_b64_tr_b16 a[252:253], v11 offset:14336
    ds_read_b64_tr_b16 a[254:255], v11 offset:14848
    v_mul_f32 v198, v166, v198
    v_mul_f32 v199, v167, v199
    v_mul_f32 v164, v20, v164
    v_mul_f32 v165, v20, v165
    v_mul_f32 v166, v20, v166
    v_mfma_f32_32x32x16_bf16 v[208:223], a[232:235], v[100:103], v[208:223]
    ds_read_b64_tr_b16 a[224:225], v11 offset:16384
    ds_read_b64_tr_b16 a[226:227], v11 offset:16896
    buffer_load_dwordx4 a[104:107], v6, s[36:39], s78 offen offset:2048 sc1
    v_mul_f32 v167, v20, v167
    v_exp_f32 v164, v164
    v_mfma_f32_32x32x16_bf16 v[224:239], a[236:239], v[100:103], v[224:239]
    s_waitcnt lgkmcnt(6)
    ds_read_b64_tr_b16 a[228:229], v11 offset:18432
    ds_read_b64_tr_b16 a[230:231], v11 offset:18944
    v_exp_f32 v165, v165
    v_exp_f32 v166, v166
    v_mfma_f32_32x32x16_bf16 v[208:223], a[240:243], v[104:107], v[208:223]
    ds_read_b64_tr_b16 a[232:233], v11 offset:20480
    ds_read_b64_tr_b16 a[234:235], v11 offset:20992
    buffer_load_dwordx4 a[108:111], v7, s[36:39], s78 offen offset:2048 sc1
    v_exp_f32 v167, v167
    v_fma_f32 v164, v164, v21, v21
    v_fma_f32 v165, v165, v21, v21
    v_fma_f32 v166, v166, v21, v21
    v_mfma_f32_32x32x16_bf16 v[224:239], a[244:247], v[104:107], v[224:239]
    s_waitcnt lgkmcnt(6)
    ds_read_b64_tr_b16 a[236:237], v11 offset:22528
    ds_read_b64_tr_b16 a[238:239], v11 offset:23040
    v_fma_f32 v167, v167, v21, v21
    v_rcp_f32 v164, v164
    v_rcp_f32 v165, v165
    v_mfma_f32_32x32x16_bf16 v[208:223], a[248:251], v[108:111], v[208:223]
    ds_read_b64_tr_b16 a[240:241], v11 offset:24576
    ds_read_b64_tr_b16 a[242:243], v11 offset:25088
    v_rcp_f32 v166, v166
    v_rcp_f32 v167, v167
    v_mfma_f32_32x32x16_bf16 v[224:239], a[252:255], v[108:111], v[224:239]
    s_waitcnt lgkmcnt(6)
    ds_read_b64_tr_b16 a[244:245], v11 offset:26624
    ds_read_b64_tr_b16 a[246:247], v11 offset:27136
    v_add_u32 v6, 0x1000, v6
    v_add_u32 v7, 0x1000, v7
    buffer_load_dwordx4 a[112:115], v6, s[36:39], s72 offen offset:0 sc1
    v_mul_f32 v196, v164, v196
    v_mul_f32 v197, v165, v197
    v_mfma_f32_32x32x16_bf16 v[208:223], a[224:227], v[112:115], v[208:223]
    s_waitcnt vmcnt(8)
    s_mov_b64 exec, 1
    buffer_store_dword v2, v3, s[36:39], s64 offen sc1
    s_mov_b64 exec, -1
    s_add_u32 s64, s64, 0x4000
    ds_read_b64_tr_b16 a[248:249], v11 offset:28672
    ds_read_b64_tr_b16 a[250:251], v11 offset:29184
    v_mul_f32 v198, v166, v198
    v_mul_f32 v199, v167, v199
    v_cvt_pk_bf16_f32 v162, v196, v197
    v_mfma_f32_32x32x16_bf16 v[224:239], a[228:231], v[112:115], v[224:239]
    s_waitcnt lgkmcnt(6)
    ds_read_b64_tr_b16 a[252:253], v11 offset:30720
    ds_read_b64_tr_b16 a[254:255], v11 offset:31232
    buffer_load_dwordx4 a[116:119], v7, s[36:39], s72 offen offset:0 sc1
    v_cvt_pk_bf16_f32 v163, v198, v199
    v_mul_f32 v200, v168, v200
    v_mul_f32 v201, v169, v201
    v_mul_f32 v202, v170, v202
    v_mfma_f32_32x32x16_bf16 v[208:223], a[232:235], v[116:119], v[208:223]
    buffer_store_dwordx4 v[160:163], v1, s[36:39], s66 offen offset:2048 sc1
    ds_read_b64_tr_b16 a[224:225], v11 offset:32768
    ds_read_b64_tr_b16 a[226:227], v11 offset:33280
    v_mul_f32 v203, v171, v203
    v_mul_f32 v168, v20, v168
    v_mul_f32 v169, v20, v169
    v_mul_f32 v170, v20, v170
    v_mfma_f32_32x32x16_bf16 v[224:239], a[236:239], v[116:119], v[224:239]
    s_waitcnt lgkmcnt(6)
    ds_read_b64_tr_b16 a[228:229], v11 offset:34816
    ds_read_b64_tr_b16 a[230:231], v11 offset:35328
    buffer_load_dwordx4 a[120:123], v6, s[36:39], s73 offen offset:0 sc1
    v_mul_f32 v171, v20, v171
    v_exp_f32 v168, v168
    v_mfma_f32_32x32x16_bf16 v[208:223], a[240:243], v[120:123], v[208:223]
    ds_read_b64_tr_b16 a[232:233], v11 offset:36864
    ds_read_b64_tr_b16 a[234:235], v11 offset:37376
    v_exp_f32 v169, v169
    v_exp_f32 v170, v170
    v_exp_f32 v171, v171
    v_mfma_f32_32x32x16_bf16 v[224:239], a[244:247], v[120:123], v[224:239]
    s_waitcnt lgkmcnt(6)
    ds_read_b64_tr_b16 a[236:237], v11 offset:38912
    ds_read_b64_tr_b16 a[238:239], v11 offset:39424
    v_fma_f32 v168, v168, v21, v21
    v_fma_f32 v169, v169, v21, v21
    v_fma_f32 v170, v170, v21, v21
    v_fma_f32 v171, v171, v21, v21
    v_mfma_f32_32x32x16_bf16 v[208:223], a[248:251], v[124:127], v[208:223]
    ds_read_b64_tr_b16 a[240:241], v11 offset:40960
    ds_read_b64_tr_b16 a[242:243], v11 offset:41472
    buffer_load_dwordx4 a[124:127], v7, s[36:39], s73 offen offset:0 sc1
    v_rcp_f32 v168, v168
    v_rcp_f32 v169, v169
    v_mfma_f32_32x32x16_bf16 v[224:239], a[252:255], v[124:127], v[224:239]
    s_waitcnt lgkmcnt(6)
    ds_read_b64_tr_b16 a[244:245], v11 offset:43008
    ds_read_b64_tr_b16 a[246:247], v11 offset:43520
    v_rcp_f32 v170, v170
    v_rcp_f32 v171, v171
    v_mul_f32 v200, v168, v200
    v_mfma_f32_32x32x16_bf16 v[208:223], a[224:227], v[128:131], v[208:223]
    ds_read_b64_tr_b16 a[248:249], v11 offset:45056
    ds_read_b64_tr_b16 a[250:251], v11 offset:45568
    buffer_load_dwordx4 a[128:131], v6, s[36:39], s74 offen offset:0 sc1
    v_mul_f32 v201, v169, v201
    v_mul_f32 v202, v170, v202
    v_mul_f32 v203, v171, v203
    v_cvt_pk_bf16_f32 v168, v200, v201
    v_mfma_f32_32x32x16_bf16 v[224:239], a[228:231], v[128:131], v[224:239]
    s_waitcnt lgkmcnt(6)
    ds_read_b64_tr_b16 a[252:253], v11 offset:47104
    ds_read_b64_tr_b16 a[254:255], v11 offset:47616
    v_cvt_pk_bf16_f32 v169, v202, v203
    v_mul_f32 v204, v172, v204
    v_mul_f32 v205, v173, v205
    v_mul_f32 v206, v174, v206
    v_mfma_f32_32x32x16_bf16 v[208:223], a[232:235], v[132:135], v[208:223]
    ds_read_b64_tr_b16 a[224:225], v14 offset:32768
    ds_read_b64_tr_b16 a[226:227], v14 offset:33280
    buffer_load_dwordx4 a[132:135], v7, s[36:39], s74 offen offset:0 sc1
    v_mul_f32 v207, v175, v207
    v_mul_f32 v172, v20, v172
    v_mul_f32 v173, v20, v173
    v_mul_f32 v174, v20, v174
    v_mfma_f32_32x32x16_bf16 v[224:239], a[236:239], v[132:135], v[224:239]
    s_waitcnt lgkmcnt(6)
    ds_read_b64_tr_b16 a[228:229], v14 offset:34816
    ds_read_b64_tr_b16 a[230:231], v14 offset:35328
    v_mul_f32 v175, v20, v175
    v_exp_f32 v172, v172
    v_mfma_f32_32x32x16_bf16 v[208:223], a[240:243], v[136:139], v[208:223]
    ds_read_b64_tr_b16 a[232:233], v14 offset:36864
    ds_read_b64_tr_b16 a[234:235], v14 offset:37376
    v_exp_f32 v173, v173
    v_exp_f32 v174, v174
    v_exp_f32 v175, v175
    v_mfma_f32_32x32x16_bf16 v[224:239], a[244:247], v[136:139], v[224:239]
    s_waitcnt lgkmcnt(6)
    ds_read_b64_tr_b16 a[236:237], v14 offset:38912
    ds_read_b64_tr_b16 a[238:239], v14 offset:39424
    buffer_load_dwordx4 a[136:139], v6, s[36:39], s75 offen offset:0 sc1
    v_fma_f32 v172, v172, v21, v21
    v_fma_f32 v173, v173, v21, v21
    v_fma_f32 v174, v174, v21, v21
    v_fma_f32 v175, v175, v21, v21
    v_mfma_f32_32x32x16_bf16 v[208:223], a[248:251], v[140:143], v[208:223]
    ds_read_b64_tr_b16 a[240:241], v14 offset:40960
    ds_read_b64_tr_b16 a[242:243], v14 offset:41472
    v_rcp_f32 v172, v172
    v_rcp_f32 v173, v173
    v_mfma_f32_32x32x16_bf16 v[224:239], a[252:255], v[140:143], v[224:239]
    s_waitcnt lgkmcnt(6)
    ds_read_b64_tr_b16 a[244:245], v14 offset:43008
    ds_read_b64_tr_b16 a[246:247], v14 offset:43520
    buffer_load_dwordx4 a[140:143], v7, s[36:39], s75 offen offset:0 sc1
    v_rcp_f32 v174, v174
    v_rcp_f32 v175, v175
    v_mfma_f32_32x32x16_bf16 v[144:159], a[224:227], v[32:35], 0
    v_mul_f32 v204, v172, v204
    v_mul_f32 v205, v173, v205
    v_mul_f32 v206, v174, v206
    v_mul_f32 v207, v175, v207
    v_cvt_pk_bf16_f32 v170, v204, v205
    v_cvt_pk_bf16_f32 v171, v206, v207
    v_mfma_f32_32x32x16_bf16 v[176:191], a[228:231], v[32:35], 0
    buffer_store_dwordx4 v[168:171], v1, s[36:39], s66 offen offset:3072 sc1
    s_waitcnt lgkmcnt(4)
    ds_read_b64_tr_b16 a[248:249], v14 offset:45056
    ds_read_b64_tr_b16 a[250:251], v14 offset:45568
    ds_read_b64_tr_b16 a[252:253], v14 offset:47104
    ds_read_b64_tr_b16 a[254:255], v14 offset:47616
    buffer_load_dwordx4 a[144:147], v6, s[36:39], s76 offen offset:0 sc1
    v_mfma_f32_32x32x16_bf16 v[144:159], a[232:235], v[36:39], v[144:159]
    ds_read_b64_tr_b16 a[224:225], v14 offset:49152
    ds_read_b64_tr_b16 a[226:227], v14 offset:49664
    v_mul_f32 v224, v208, v224
    v_mul_f32 v225, v209, v225
    v_mul_f32 v226, v210, v226
    v_mul_f32 v227, v211, v227
    v_mul_f32 v208, v20, v208
    v_mul_f32 v209, v20, v209
    v_mfma_f32_32x32x16_bf16 v[176:191], a[236:239], v[36:39], v[176:191]
    s_waitcnt lgkmcnt(6)
    ds_read_b64_tr_b16 a[228:229], v14 offset:51200
    ds_read_b64_tr_b16 a[230:231], v14 offset:51712
    buffer_load_dwordx4 a[148:151], v7, s[36:39], s76 offen offset:0 sc1
    v_mul_f32 v210, v20, v210
    v_mul_f32 v211, v20, v211
    v_exp_f32 v208, v208
    v_mfma_f32_32x32x16_bf16 v[144:159], a[240:243], v[40:43], v[144:159]
    ds_read_b64_tr_b16 a[232:233], v14 offset:53248
    ds_read_b64_tr_b16 a[234:235], v14 offset:53760
    v_exp_f32 v209, v209
    v_exp_f32 v210, v210
    v_mfma_f32_32x32x16_bf16 v[176:191], a[244:247], v[40:43], v[176:191]
    s_waitcnt lgkmcnt(6)
    ds_read_b64_tr_b16 a[236:237], v14 offset:55296
    ds_read_b64_tr_b16 a[238:239], v14 offset:55808
    v_exp_f32 v211, v211
    v_fma_f32 v208, v208, v21, v21
    v_fma_f32 v209, v209, v21, v21
    v_fma_f32 v210, v210, v21, v21
    v_mfma_f32_32x32x16_bf16 v[144:159], a[248:251], v[44:47], v[144:159]
    ds_read_b64_tr_b16 a[240:241], v14 offset:57344
    ds_read_b64_tr_b16 a[242:243], v14 offset:57856
    buffer_load_dwordx4 a[152:155], v6, s[36:39], s77 offen offset:0 sc1
    v_fma_f32 v211, v211, v21, v21
    v_rcp_f32 v208, v208
    v_rcp_f32 v209, v209
    v_mfma_f32_32x32x16_bf16 v[176:191], a[252:255], v[44:47], v[176:191]
    s_waitcnt lgkmcnt(6)
    ds_read_b64_tr_b16 a[244:245], v14 offset:59392
    ds_read_b64_tr_b16 a[246:247], v14 offset:59904
    v_rcp_f32 v210, v210
    v_rcp_f32 v211, v211
    v_mfma_f32_32x32x16_bf16 v[144:159], a[224:227], v[48:51], v[144:159]
    ds_read_b64_tr_b16 a[248:249], v14 offset:61440
    ds_read_b64_tr_b16 a[250:251], v14 offset:61952
    buffer_load_dwordx4 a[156:159], v7, s[36:39], s77 offen offset:0 sc1
    v_mul_f32 v224, v208, v224
    v_mul_f32 v225, v209, v225
    v_mul_f32 v226, v210, v226
    v_mul_f32 v227, v211, v227
    v_mfma_f32_32x32x16_bf16 v[176:191], a[228:231], v[48:51], v[176:191]
    s_waitcnt lgkmcnt(6)
    ds_read_b64_tr_b16 a[252:253], v14 offset:63488
    ds_read_b64_tr_b16 a[254:255], v14 offset:64000
    v_cvt_pk_bf16_f32 v208, v224, v225
    v_cvt_pk_bf16_f32 v209, v226, v227
    v_mul_f32 v228, v212, v228
    v_mul_f32 v229, v213, v229
    v_mul_f32 v230, v214, v230
    v_mfma_f32_32x32x16_bf16 v[144:159], a[232:235], v[52:55], v[144:159]
    ds_read_b64_tr_b16 a[224:225], v16 offset:0
    ds_read_b64_tr_b16 a[226:227], v16 offset:512
    buffer_load_dwordx4 a[160:163], v6, s[36:39], s78 offen offset:0 sc1
    v_mul_f32 v231, v215, v231
    v_mul_f32 v212, v20, v212
    v_mul_f32 v213, v20, v213
    v_mul_f32 v214, v20, v214
    v_mfma_f32_32x32x16_bf16 v[176:191], a[236:239], v[52:55], v[176:191]
    s_waitcnt lgkmcnt(6)
    ds_read_b64_tr_b16 a[228:229], v16 offset:2048
    ds_read_b64_tr_b16 a[230:231], v16 offset:2560
    v_mul_f32 v215, v20, v215
    v_exp_f32 v212, v212
    v_mfma_f32_32x32x16_bf16 v[144:159], a[240:243], v[56:59], v[144:159]
    ds_read_b64_tr_b16 a[232:233], v16 offset:4096
    ds_read_b64_tr_b16 a[234:235], v16 offset:4608
    v_exp_f32 v213, v213
    v_exp_f32 v214, v214
    v_exp_f32 v215, v215
    v_mfma_f32_32x32x16_bf16 v[176:191], a[244:247], v[56:59], v[176:191]
    s_waitcnt lgkmcnt(6)
    ds_read_b64_tr_b16 a[236:237], v16 offset:6144
    ds_read_b64_tr_b16 a[238:239], v16 offset:6656
    buffer_load_dwordx4 a[164:167], v7, s[36:39], s78 offen offset:0 sc1
    v_fma_f32 v212, v212, v21, v21
    v_fma_f32 v213, v213, v21, v21
    v_fma_f32 v214, v214, v21, v21
    v_fma_f32 v215, v215, v21, v21
    v_mfma_f32_32x32x16_bf16 v[144:159], a[248:251], v[60:63], v[144:159]
    ds_read_b64_tr_b16 a[240:241], v16 offset:8192
    ds_read_b64_tr_b16 a[242:243], v16 offset:8704
    v_rcp_f32 v212, v212
    v_rcp_f32 v213, v213
    v_mfma_f32_32x32x16_bf16 v[176:191], a[252:255], v[60:63], v[176:191]
    s_waitcnt lgkmcnt(6)
    ds_read_b64_tr_b16 a[244:245], v16 offset:10240
    ds_read_b64_tr_b16 a[246:247], v16 offset:10752
    buffer_load_dwordx4 a[168:171], v6, s[36:39], s72 offen offset:2048 sc1
    v_rcp_f32 v214, v214
    v_rcp_f32 v215, v215
    v_mul_f32 v228, v212, v228
    v_mfma_f32_32x32x16_bf16 v[144:159], a[224:227], v[64:67], v[144:159]
    ds_read_b64_tr_b16 a[248:249], v16 offset:12288
    ds_read_b64_tr_b16 a[250:251], v16 offset:12800
    v_mul_f32 v229, v213, v229
    v_mul_f32 v230, v214, v230
    v_mul_f32 v231, v215, v231
    v_cvt_pk_bf16_f32 v210, v228, v229
    v_cvt_pk_bf16_f32 v211, v230, v231
    v_mfma_f32_32x32x16_bf16 v[176:191], a[228:231], v[64:67], v[176:191]
    s_waitcnt lgkmcnt(6)
    ds_read_b64_tr_b16 a[252:253], v16 offset:14336
    ds_read_b64_tr_b16 a[254:255], v16 offset:14848
    buffer_load_dwordx4 a[172:175], v7, s[36:39], s72 offen offset:2048 sc1
    buffer_store_dwordx4 v[208:211], v1, s[36:39], s67 offen offset:0 sc1
    v_mul_f32 v232, v216, v232
    v_mul_f32 v233, v217, v233
    v_mul_f32 v234, v218, v234
    v_mfma_f32_32x32x16_bf16 v[144:159], a[232:235], v[68:71], v[144:159]
    buffer_load_dword v27, v17, s[36:39], s65 offen sc1
    s_waitcnt vmcnt(10)
    s_mov_b64 exec, 1
    buffer_store_dword v2, v3, s[36:39], s64 offen sc1
    s_mov_b64 exec, -1
    s_add_u32 s64, s64, 0x4000
    ds_read_b64_tr_b16 a[224:225], v16 offset:16384
    ds_read_b64_tr_b16 a[226:227], v16 offset:16896
    v_mul_f32 v235, v219, v235
    v_mul_f32 v216, v20, v216
    v_mul_f32 v217, v20, v217
    v_mfma_f32_32x32x16_bf16 v[176:191], a[236:239], v[68:71], v[176:191]
    s_waitcnt lgkmcnt(6)
    ds_read_b64_tr_b16 a[228:229], v16 offset:18432
    ds_read_b64_tr_b16 a[230:231], v16 offset:18944
    v_mul_f32 v218, v20, v218
    v_mul_f32 v219, v20, v219
    v_exp_f32 v216, v216
    v_mfma_f32_32x32x16_bf16 v[144:159], a[240:243], v[72:75], v[144:159]
    ds_read_b64_tr_b16 a[232:233], v16 offset:20480
    ds_read_b64_tr_b16 a[234:235], v16 offset:20992
    buffer_load_dwordx4 a[176:179], v6, s[36:39], s73 offen offset:2048 sc1
    v_exp_f32 v217, v217
    v_exp_f32 v218, v218
    v_mfma_f32_32x32x16_bf16 v[176:191], a[244:247], v[72:75], v[176:191]
    s_waitcnt lgkmcnt(6)
    ds_read_b64_tr_b16 a[236:237], v16 offset:22528
    ds_read_b64_tr_b16 a[238:239], v16 offset:23040
    v_exp_f32 v219, v219
    v_fma_f32 v216, v216, v21, v21
    v_fma_f32 v217, v217, v21, v21
    v_fma_f32 v218, v218, v21, v21
    v_mfma_f32_32x32x16_bf16 v[144:159], a[248:251], v[76:79], v[144:159]
    ds_read_b64_tr_b16 a[240:241], v16 offset:24576
    ds_read_b64_tr_b16 a[242:243], v16 offset:25088
    buffer_load_dwordx4 a[180:183], v7, s[36:39], s73 offen offset:2048 sc1
    v_fma_f32 v219, v219, v21, v21
    v_rcp_f32 v216, v216
    v_mfma_f32_32x32x16_bf16 v[176:191], a[252:255], v[76:79], v[176:191]
    s_waitcnt lgkmcnt(6)
    ds_read_b64_tr_b16 a[244:245], v16 offset:26624
    ds_read_b64_tr_b16 a[246:247], v16 offset:27136
    v_rcp_f32 v217, v217
    v_rcp_f32 v218, v218
    v_rcp_f32 v219, v219
    v_mfma_f32_32x32x16_bf16 v[144:159], a[224:227], v[80:83], v[144:159]
    ds_read_b64_tr_b16 a[248:249], v16 offset:28672
    ds_read_b64_tr_b16 a[250:251], v16 offset:29184
    buffer_load_dwordx4 a[184:187], v6, s[36:39], s74 offen offset:2048 sc1
    v_mul_f32 v232, v216, v232
    v_mul_f32 v233, v217, v233
    v_mul_f32 v234, v218, v234
    v_mul_f32 v235, v219, v235
    v_mfma_f32_32x32x16_bf16 v[176:191], a[228:231], v[80:83], v[176:191]
    s_waitcnt lgkmcnt(6)
    ds_read_b64_tr_b16 a[252:253], v16 offset:30720
    ds_read_b64_tr_b16 a[254:255], v16 offset:31232
    v_cvt_pk_bf16_f32 v216, v232, v233
    v_cvt_pk_bf16_f32 v217, v234, v235
    v_mul_f32 v236, v220, v236
    v_mul_f32 v237, v221, v237
    v_mfma_f32_32x32x16_bf16 v[144:159], a[232:235], v[84:87], v[144:159]
    ds_read_b64_tr_b16 a[224:225], v12 offset:0
    ds_read_b64_tr_b16 a[226:227], v12 offset:512
    buffer_load_dwordx4 a[188:191], v7, s[36:39], s74 offen offset:2048 sc1
    v_mul_f32 v238, v222, v238
    v_mul_f32 v239, v223, v239
    v_mul_f32 v220, v20, v220
    v_mul_f32 v221, v20, v221
    v_mfma_f32_32x32x16_bf16 v[176:191], a[236:239], v[84:87], v[176:191]
    s_waitcnt lgkmcnt(6)
    ds_read_b64_tr_b16 a[228:229], v12 offset:2048
    ds_read_b64_tr_b16 a[230:231], v12 offset:2560
    v_mul_f32 v222, v20, v222
    v_mul_f32 v223, v20, v223
    v_exp_f32 v220, v220
    v_mfma_f32_32x32x16_bf16 v[144:159], a[240:243], v[88:91], v[144:159]
    ds_read_b64_tr_b16 a[232:233], v12 offset:4096
    ds_read_b64_tr_b16 a[234:235], v12 offset:4608
    v_exp_f32 v221, v221
    v_exp_f32 v222, v222
    v_exp_f32 v223, v223
    v_mfma_f32_32x32x16_bf16 v[176:191], a[244:247], v[88:91], v[176:191]
    s_waitcnt lgkmcnt(6)
    ds_read_b64_tr_b16 a[236:237], v12 offset:6144
    ds_read_b64_tr_b16 a[238:239], v12 offset:6656
    buffer_load_dwordx4 a[192:195], v6, s[36:39], s75 offen offset:2048 sc1
    v_fma_f32 v220, v220, v21, v21
    v_fma_f32 v221, v221, v21, v21
    v_fma_f32 v222, v222, v21, v21
    v_fma_f32 v223, v223, v21, v21
    v_mfma_f32_32x32x16_bf16 v[144:159], a[248:251], v[92:95], v[144:159]
    ds_read_b64_tr_b16 a[240:241], v12 offset:8192
    ds_read_b64_tr_b16 a[242:243], v12 offset:8704
    v_rcp_f32 v220, v220
    v_rcp_f32 v221, v221
    v_mfma_f32_32x32x16_bf16 v[176:191], a[252:255], v[92:95], v[176:191]
    s_waitcnt lgkmcnt(6)
    ds_read_b64_tr_b16 a[244:245], v12 offset:10240
    ds_read_b64_tr_b16 a[246:247], v12 offset:10752
    buffer_load_dwordx4 a[196:199], v7, s[36:39], s75 offen offset:2048 sc1
    v_rcp_f32 v222, v222
    v_rcp_f32 v223, v223
    v_mfma_f32_32x32x16_bf16 v[144:159], a[224:227], v[96:99], v[144:159]
    v_mul_f32 v236, v220, v236
    v_mul_f32 v237, v221, v237
    v_mul_f32 v238, v222, v238
    v_mul_f32 v239, v223, v239
    v_cvt_pk_bf16_f32 v218, v236, v237
    v_cvt_pk_bf16_f32 v219, v238, v239
    v_mfma_f32_32x32x16_bf16 v[176:191], a[228:231], v[96:99], v[176:191]
    buffer_store_dwordx4 v[216:219], v1, s[36:39], s67 offen offset:1024 sc1
    s_waitcnt lgkmcnt(4)
    s_barrier
    ds_read_b64_tr_b16 a[248:249], v12 offset:12288
    ds_read_b64_tr_b16 a[250:251], v12 offset:12800
    ds_read_b64_tr_b16 a[252:253], v12 offset:14336
    ds_read_b64_tr_b16 a[254:255], v12 offset:14848
    buffer_load_dwordx4 a[200:203], v6, s[36:39], s76 offen offset:2048 sc1
    v_mfma_f32_32x32x16_bf16 v[144:159], a[232:235], v[100:103], v[144:159]
    s_waitcnt vmcnt(9)
    v_cmp_eq_u32 vcc, 0, v27
    s_nop 0
    s_cbranch_vccnz L_slow_h0
L_ok_h0:
    s_add_u32 s65, s65, 0x4000
    ds_read_b64_tr_b16 a[224:225], v12 offset:16384
    ds_read_b64_tr_b16 a[226:227], v12 offset:16896
    s_lshl_b32 s60, s54, 6
    s_and_b32 s61, s48, 1
    s_lshl_b32 s61, s61, 5
    s_add_u32 s60, s60, s61
    v_and_b32 v13, 31, v0
    v_add_u32 v13, s60, v13
    v_cvt_f32_u32 v13, v13
    v_mfma_f32_32x32x16_bf16 v[176:191], a[236:239], v[100:103], v[176:191]
    s_waitcnt lgkmcnt(6)
    ds_read_b64_tr_b16 a[228:229], v12 offset:18432
    ds_read_b64_tr_b16 a[230:231], v12 offset:18944
    s_lshr_b32 s60, s48, 1
    v_mul_f32 v13, 0x3b124925, v13
    v_lshrrev_b32 v14, 5, v0
    v_and_b32 v4, s60, v14
    v_cvt_f32_u32 v4, v4
    v_mfma_f32_32x32x16_bf16 v[144:159], a[240:243], v[104:107], v[144:159]
    ds_read_b64_tr_b16 a[232:233], v12 offset:20480
    ds_read_b64_tr_b16 a[234:235], v12 offset:20992
    buffer_load_dwordx4 v[32:35], v8, s[36:39], s79 offen offset:0 sc1
    s_mul_i32 s60, s60, 112
    s_add_u32 s60, s60, 1
    v_fma_f32 v4, v4, -0.5, 1.0
    v_lshl_add_u32 v14, v14, 2, s60
    v_cvt_f32_u32 v14, v14
    v_mfma_f32_32x32x16_bf16 v[176:191], a[244:247], v[104:107], v[176:191]
    s_waitcnt lgkmcnt(6)
    ds_read_b64_tr_b16 a[236:237], v12 offset:22528
    ds_read_b64_tr_b16 a[238:239], v12 offset:23040
    v_mul_f32 v14, v14, v13
    v_fmamk_f32 v244, v13, 0x0, v14
    v_fmamk_f32 v245, v13, 0x3f800000, v14
    v_fmamk_f32 v246, v13, 0x40000000, v14
    v_mfma_f32_32x32x16_bf16 v[144:159], a[248:251], v[108:111], v[144:159]
    ds_read_b64_tr_b16 a[240:241], v12 offset:24576
    ds_read_b64_tr_b16 a[242:243], v12 offset:25088
    buffer_load_dwordx4 v[36:39], v9, s[36:39], s79 offen offset:0 sc1
    v_fmamk_f32 v247, v13, 0x40400000, v14
    v_cos_f32 v240, v244
    v_mfma_f32_32x32x16_bf16 v[176:191], a[252:255], v[108:111], v[176:191]
    s_waitcnt lgkmcnt(6)
    ds_read_b64_tr_b16 a[244:245], v12 offset:26624
    ds_read_b64_tr_b16 a[246:247], v12 offset:27136
    v_cos_f32 v241, v245
    v_cos_f32 v242, v246
    v_mfma_f32_32x32x16_bf16 v[144:159], a[224:227], v[112:115], v[144:159]
    ds_read_b64_tr_b16 a[248:249], v12 offset:28672
    ds_read_b64_tr_b16 a[250:251], v12 offset:29184
    buffer_load_dwordx4 v[40:43], v8, s[36:39], s80 offen offset:0 sc1
    v_cos_f32 v243, v247
    v_sin_f32 v244, v244
    v_mfma_f32_32x32x16_bf16 v[176:191], a[228:231], v[112:115], v[176:191]
    s_waitcnt lgkmcnt(6)
    ds_read_b64_tr_b16 a[252:253], v12 offset:30720
    ds_read_b64_tr_b16 a[254:255], v12 offset:31232
    v_sin_f32 v245, v245
    v_sin_f32 v246, v246
    v_mfma_f32_32x32x16_bf16 v[144:159], a[232:235], v[116:119], v[144:159]
    ds_read_b64_tr_b16 a[224:225], v12 offset:32768
    ds_read_b64_tr_b16 a[226:227], v12 offset:33280
    v_sin_f32 v247, v247
    v_cvt_pk_bf16_f32 v240, v240, v241
    v_cvt_pk_bf16_f32 v241, v242, v243
    v_mfma_f32_32x32x16_bf16 v[176:191], a[236:239], v[116:119], v[176:191]
    s_waitcnt lgkmcnt(6)
    ds_read_b64_tr_b16 a[228:229], v12 offset:34816
    ds_read_b64_tr_b16 a[230:231], v12 offset:35328
    buffer_load_dwordx4 v[44:47], v9, s[36:39], s80 offen offset:0 sc1
    v_cvt_pk_bf16_f32 v242, -v244, -v245
    v_cvt_pk_bf16_f32 v243, -v246, -v247
    v_mfma_f32_32x32x16_bf16 v[144:159], a[240:243], v[120:123], v[144:159]
    ds_read_b64_tr_b16 a[232:233], v12 offset:36864
    ds_read_b64_tr_b16 a[234:235], v12 offset:37376
    v_mfma_f32_32x32x16_bf16 v[176:191], a[244:247], v[120:123], v[176:191]
    s_waitcnt lgkmcnt(6)
    ds_read_b64_tr_b16 a[236:237], v12 offset:38912
    ds_read_b64_tr_b16 a[238:239], v12 offset:39424
    buffer_load_dwordx4 v[48:51], v8, s[36:39], s81 offen offset:0 sc1
    v_mfma_f32_32x32x16_bf16 v[144:159], a[248:251], v[124:127], v[144:159]
    ds_read_b64_tr_b16 a[240:241], v12 offset:40960
    ds_read_b64_tr_b16 a[242:243], v12 offset:41472
    v_mfma_f32_32x32x16_bf16 v[176:191], a[252:255], v[124:127], v[176:191]
    s_waitcnt lgkmcnt(6)
    ds_read_b64_tr_b16 a[244:245], v12 offset:43008
    ds_read_b64_tr_b16 a[246:247], v12 offset:43520
    buffer_load_dwordx4 v[52:55], v9, s[36:39], s81 offen offset:0 sc1
    v_mfma_f32_32x32x16_bf16 v[144:159], a[224:227], v[128:131], v[144:159]
    ds_read_b64_tr_b16 a[248:249], v12 offset:45056
    ds_read_b64_tr_b16 a[250:251], v12 offset:45568
    v_mfma_f32_32x32x16_bf16 v[176:191], a[228:231], v[128:131], v[176:191]
    s_waitcnt lgkmcnt(6)
    ds_read_b64_tr_b16 a[252:253], v12 offset:47104
    ds_read_b64_tr_b16 a[254:255], v12 offset:47616
    buffer_load_dwordx4 v[56:59], v8, s[36:39], s82 offen offset:0 sc1
    v_mfma_f32_32x32x16_bf16 v[144:159], a[232:235], v[132:135], v[144:159]
    s_waitcnt vmcnt(8)
    s_mov_b64 exec, 1
    buffer_store_dword v2, v3, s[36:39], s64 offen sc1
    s_mov_b64 exec, -1
    s_add_u32 s64, s64, 0x4000
    ds_write_b128 v26, v[240:243] offset:0
    v_fmamk_f32 v252, v13, 0x41000000, v14
    v_fmamk_f32 v253, v13, 0x41100000, v14
    v_mfma_f32_32x32x16_bf16 v[176:191], a[236:239], v[132:135], v[176:191]
    s_waitcnt lgkmcnt(5)
    v_fmamk_f32 v254, v13, 0x41200000, v14
    v_fmamk_f32 v255, v13, 0x41300000, v14
    v_cos_f32 v248, v252
    v_mfma_f32_32x32x16_bf16 v[144:159], a[240:243], v[136:139], v[144:159]
    buffer_load_dwordx4 v[60:63], v9, s[36:39], s82 offen offset:0 sc1
    buffer_load_dword v27, v17, s[36:39], s65 offen sc1
    v_cos_f32 v249, v253
    v_cos_f32 v250, v254
    v_mfma_f32_32x32x16_bf16 v[176:191], a[244:247], v[136:139], v[176:191]
    s_waitcnt lgkmcnt(1)
    v_cos_f32 v251, v255
    v_sin_f32 v252, v252
    v_sin_f32 v253, v253
    v_mfma_f32_32x32x16_bf16 v[144:159], a[248:251], v[140:143], v[144:159]
    buffer_load_dwordx4 v[64:67], v8, s[36:39], s83 offen offset:0 sc1
    v_sin_f32 v254, v254
    v_sin_f32 v255, v255
    v_cvt_pk_bf16_f32 v248, v248, v249
    v_mfma_f32_32x32x16_bf16 v[176:191], a[252:255], v[140:143], v[176:191]
    v_cvt_pk_bf16_f32 v249, v250, v251
    v_cvt_pk_bf16_f32 v250, -v252, -v253
    v_cvt_pk_bf16_f32 v251, -v254, -v255
    buffer_load_dwordx4 v[68:71], v9, s[36:39], s83 offen offset:0 sc1
    s_nop 7
    v_pk_mul_f32 v[176:177], v[144:145], v[176:177]
    v_pk_mul_f32 v[178:179], v[146:147], v[178:179]
    v_pk_mul_f32 v[180:181], v[148:149], v[180:181]
    v_pk_mul_f32 v[182:183], v[150:151], v[182:183]
    v_pk_mul_f32 v[144:145], v[144:145], v[20:21] op_sel_hi:[1,0]
    v_pk_mul_f32 v[146:147], v[146:147], v[20:21] op_sel_hi:[1,0]
    v_pk_mul_f32 v[148:149], v[148:149], v[20:21] op_sel_hi:[1,0]
    v_pk_mul_f32 v[150:151], v[150:151], v[20:21] op_sel_hi:[1,0]
    v_exp_f32 v144, v144
    v_exp_f32 v145, v145
    v_exp_f32 v146, v146
    v_exp_f32 v147, v147
    v_exp_f32 v148, v148
    v_add_u32 v11, 0x1000, v8
    v_add_u32 v12, 0x1000, v9
    v_exp_f32 v149, v149
    v_exp_f32 v150, v150
    v_exp_f32 v151, v151
    v_pk_fma_f32 v[144:145], v[144:145], v[20:21], v[20:21] op_sel:[0,1,1] op_sel_hi:[1,1,1]
    v_pk_fma_f32 v[146:147], v[146:147], v[20:21], v[20:21] op_sel:[0,1,1] op_sel_hi:[1,1,1]
    v_pk_fma_f32 v[148:149], v[148:149], v[20:21], v[20:21] op_sel:[0,1,1] op_sel_hi:[1,1,1]
    v_pk_fma_f32 v[150:151], v[150:151], v[20:21], v[20:21] op_sel:[0,1,1] op_sel_hi:[1,1,1]
    v_rcp_f32 v144, v144
    v_rcp_f32 v145, v145
    v_rcp_f32 v146, v146
    buffer_load_dwordx4 v[72:75], v8, s[36:39], s84 offen offset:0 sc1
    v_rcp_f32 v147, v147
    v_rcp_f32 v148, v148
    v_rcp_f32 v149, v149
    v_rcp_f32 v150, v150
    v_rcp_f32 v151, v151
    v_pk_mul_f32 v[176:177], v[144:145], v[176:177]
    v_pk_mul_f32 v[178:179], v[146:147], v[178:179]
    v_pk_mul_f32 v[180:181], v[148:149], v[180:181]
    v_pk_mul_f32 v[182:183], v[150:151], v[182:183]
    v_cvt_pk_bf16_f32 v144, v176, v177
    v_cvt_pk_bf16_f32 v145, v178, v179
    v_cvt_pk_bf16_f32 v146, v180, v181
    v_cvt_pk_bf16_f32 v147, v182, v183
    buffer_store_dwordx4 v[144:147], v1, s[36:39], s67 offen offset:2048 sc1
    buffer_load_dwordx4 v[76:79], v9, s[36:39], s84 offen offset:0 sc1
    v_pk_mul_f32 v[184:185], v[152:153], v[184:185]
    v_pk_mul_f32 v[186:187], v[154:155], v[186:187]
    v_pk_mul_f32 v[188:189], v[156:157], v[188:189]
    v_pk_mul_f32 v[190:191], v[158:159], v[190:191]
    v_pk_mul_f32 v[152:153], v[152:153], v[20:21] op_sel_hi:[1,0]
    v_pk_mul_f32 v[154:155], v[154:155], v[20:21] op_sel_hi:[1,0]
    v_pk_mul_f32 v[156:157], v[156:157], v[20:21] op_sel_hi:[1,0]
    v_pk_mul_f32 v[158:159], v[158:159], v[20:21] op_sel_hi:[1,0]
    v_exp_f32 v152, v152
    v_exp_f32 v153, v153
    v_exp_f32 v154, v154
    v_exp_f32 v155, v155
    v_exp_f32 v156, v156
    v_exp_f32 v157, v157
    v_exp_f32 v158, v158
    v_exp_f32 v159, v159
    v_pk_fma_f32 v[152:153], v[152:153], v[20:21], v[20:21] op_sel:[0,1,1] op_sel_hi:[1,1,1]
    v_pk_fma_f32 v[154:155], v[154:155], v[20:21], v[20:21] op_sel:[0,1,1] op_sel_hi:[1,1,1]
    v_pk_fma_f32 v[156:157], v[156:157], v[20:21], v[20:21] op_sel:[0,1,1] op_sel_hi:[1,1,1]
    v_pk_fma_f32 v[158:159], v[158:159], v[20:21], v[20:21] op_sel:[0,1,1] op_sel_hi:[1,1,1]
    v_rcp_f32 v152, v152
    v_rcp_f32 v153, v153
    v_rcp_f32 v154, v154
    v_rcp_f32 v155, v155
    v_rcp_f32 v156, v156
    v_rcp_f32 v157, v157
    v_rcp_f32 v158, v158
    v_rcp_f32 v159, v159
    v_pk_mul_f32 v[184:185], v[152:153], v[184:185]
    v_pk_mul_f32 v[186:187], v[154:155], v[186:187]
    v_pk_mul_f32 v[188:189], v[156:157], v[188:189]
    v_pk_mul_f32 v[190:191], v[158:159], v[190:191]
    v_cvt_pk_bf16_f32 v152, v184, v185
    v_cvt_pk_bf16_f32 v153, v186, v187
    v_cvt_pk_bf16_f32 v154, v188, v189
    v_cvt_pk_bf16_f32 v155, v190, v191
    s_waitcnt vmcnt(14)
    v_mfma_f32_32x32x16_bf16 v[160:175], a[0:3], v[32:35], 0
    buffer_store_dwordx4 v[152:155], v1, s[36:39], s67 offen offset:3072 sc1
    buffer_load_dwordx4 v[80:83], v8, s[36:39], s85 offen offset:0 sc1
    buffer_load_dwordx4 v[84:87], v9, s[36:39], s85 offen offset:0 sc1
    ds_write_b128 v26, v[248:251] offset:1024
    v_fmamk_f32 v244, v13, 0x41800000, v14
    v_fmamk_f32 v245, v13, 0x41880000, v14
    v_fmamk_f32 v246, v13, 0x41900000, v14
    v_mfma_f32_32x32x16_bf16 v[192:207], a[4:7], v[32:35], 0
    s_barrier
    s_add_u32 s62, s52, 0
    s_lshl_b32 s63, s48, 11
    s_add_u32 m0, s63, 0
    s_nop 0
    buffer_load_dwordx4 v24, s[8:11], s62 offen lds
    v_fmamk_f32 v247, v13, 0x41980000, v14
    v_cos_f32 v240, v244
    s_waitcnt vmcnt(17)
    v_mfma_f32_32x32x16_bf16 v[208:223], a[0:3], v[36:39], 0
    v_cos_f32 v241, v245
    v_cos_f32 v242, v246
    v_mfma_f32_32x32x16_bf16 v[224:239], a[4:7], v[36:39], 0
    s_add_u32 s62, s52, 458752
    s_lshl_b32 s63, s48, 11
    s_add_u32 m0, s63, 1024
    v_xor_b32 v24, 64, v24
    buffer_load_dwordx4 v24, s[8:11], s62 offen lds
    v_cos_f32 v243, v247
    v_sin_f32 v244, v244
    s_waitcnt vmcnt(17)
    v_mfma_f32_32x32x16_bf16 v[160:175], a[8:11], v[40:43], v[160:175]
    buffer_load_dwordx4 a[204:207], v7, s[36:39], s76 offen offset:2048 sc1
    v_sin_f32 v245, v245
    v_sin_f32 v246, v246
    v_mfma_f32_32x32x16_bf16 v[192:207], a[12:15], v[40:43], v[192:207]
    v_sin_f32 v247, v247
    v_cvt_pk_bf16_f32 v240, v240, v241
    v_cvt_pk_bf16_f32 v241, v242, v243
    v_cvt_pk_bf16_f32 v242, -v244, -v245
    v_cvt_pk_bf16_f32 v243, -v246, -v247
    s_waitcnt vmcnt(17)
    v_mfma_f32_32x32x16_bf16 v[208:223], a[8:11], v[44:47], v[208:223]
    buffer_load_dwordx4 a[208:211], v6, s[36:39], s77 offen offset:2048 sc1
    s_waitcnt vmcnt(12)
    v_cmp_eq_u32 vcc, 0, v27
    s_nop 0
    s_cbranch_vccnz L_slow_h1
L_ok_h1:
    s_add_u32 s65, s65, 0x4000
    ds_write_b128 v26, v[240:243] offset:2048
    v_mfma_f32_32x32x16_bf16 v[224:239], a[12:15], v[44:47], v[224:239]
    buffer_load_dwordx4 v[88:91], v8, s[36:39], s79 offen offset:2048 sc1
    v_fmamk_f32 v252, v13, 0x41c00000, v14
    v_fmamk_f32 v253, v13, 0x41c80000, v14
    v_fmamk_f32 v254, v13, 0x41d00000, v14
    v_fmamk_f32 v255, v13, 0x41d80000, v14
    v_mfma_f32_32x32x16_bf16 v[160:175], a[16:19], v[48:51], v[160:175]
    buffer_load_dwordx4 v[92:95], v9, s[36:39], s79 offen offset:2048 sc1
    v_cos_f32 v248, v252
    v_cos_f32 v249, v253
    v_cos_f32 v250, v254
    v_mfma_f32_32x32x16_bf16 v[192:207], a[20:23], v[48:51], v[192:207]
    v_cos_f32 v251, v255
    v_sin_f32 v252, v252
    v_mfma_f32_32x32x16_bf16 v[208:223], a[16:19], v[52:55], v[208:223]
    buffer_load_dwordx4 v[96:99], v8, s[36:39], s80 offen offset:2048 sc1
    v_sin_f32 v253, v253
    v_sin_f32 v254, v254
    v_mfma_f32_32x32x16_bf16 v[224:239], a[20:23], v[52:55], v[224:239]
    buffer_load_dwordx4 v[100:103], v9, s[36:39], s80 offen offset:2048 sc1
    v_sin_f32 v255, v255
    v_cvt_pk_bf16_f32 v248, v248, v249
    v_cvt_pk_bf16_f32 v249, v250, v251
    v_cvt_pk_bf16_f32 v250, -v252, -v253
    v_cvt_pk_bf16_f32 v251, -v254, -v255
    v_mfma_f32_32x32x16_bf16 v[160:175], a[24:27], v[56:59], v[160:175]
    ds_write_b128 v26, v[248:251] offset:3072
    v_fmamk_f32 v244, v13, 0x42000000, v14
    v_fmamk_f32 v245, v13, 0x42040000, v14
    v_mfma_f32_32x32x16_bf16 v[192:207], a[28:31], v[56:59], v[192:207]
    buffer_load_dwordx4 v[104:107], v8, s[36:39], s81 offen offset:2048 sc1
    v_fmamk_f32 v246, v13, 0x42080000, v14
    v_fmamk_f32 v247, v13, 0x420c0000, v14
    v_cos_f32 v240, v244
    v_mfma_f32_32x32x16_bf16 v[208:223], a[24:27], v[60:63], v[208:223]
    buffer_load_dwordx4 v[108:111], v9, s[36:39], s81 offen offset:2048 sc1
    v_cos_f32 v241, v245
    v_cos_f32 v242, v246
    v_mfma_f32_32x32x16_bf16 v[224:239], a[28:31], v[60:63], v[224:239]
    buffer_load_dwordx4 v[112:115], v8, s[36:39], s82 offen offset:2048 sc1
    v_cos_f32 v243, v247
    v_sin_f32 v244, v244
    v_sin_f32 v245, v245
    s_waitcnt vmcnt(18)
    v_mfma_f32_32x32x16_bf16 v[160:175], a[32:35], v[64:67], v[160:175]
    v_sin_f32 v246, v246
    v_sin_f32 v247, v247
    v_cvt_pk_bf16_f32 v240, v240, v241
    v_mfma_f32_32x32x16_bf16 v[192:207], a[36:39], v[64:67], v[192:207]
    buffer_load_dwordx4 v[116:119], v9, s[36:39], s82 offen offset:2048 sc1
    v_cvt_pk_bf16_f32 v241, v242, v243
    v_cvt_pk_bf16_f32 v242, -v244, -v245
    v_cvt_pk_bf16_f32 v243, -v246, -v247
    s_waitcnt vmcnt(18)
    v_mfma_f32_32x32x16_bf16 v[208:223], a[32:35], v[68:71], v[208:223]
    buffer_load_dwordx4 v[120:123], v8, s[36:39], s83 offen offset:2048 sc1
    ds_write_b128 v26, v[240:243] offset:4096
    v_fmamk_f32 v252, v13, 0x42200000, v14
    v_fmamk_f32 v253, v13, 0x42240000, v14
    v_fmamk_f32 v254, v13, 0x42280000, v14
    v_mfma_f32_32x32x16_bf16 v[224:239], a[36:39], v[68:71], v[224:239]
    v_fmamk_f32 v255, v13, 0x422c0000, v14
    v_cos_f32 v248, v252
    v_cos_f32 v249, v253
    s_waitcnt vmcnt(18)
    v_mfma_f32_32x32x16_bf16 v[160:175], a[40:43], v[72:75], v[160:175]
    buffer_load_dwordx4 v[124:127], v9, s[36:39], s83 offen offset:2048 sc1
    s_waitcnt vmcnt(16)
    s_mov_b64 exec, 1
    buffer_store_dword v2, v3, s[36:39], s64 offen sc1
    s_mov_b64 exec, -1
    s_add_u32 s64, s64, 0x4000
    v_cos_f32 v250, v254
    v_mfma_f32_32x32x16_bf16 v[192:207], a[44:47], v[72:75], v[192:207]
    buffer_load_dwordx4 v[32:35], v8, s[36:39], s84 offen offset:2048 sc1
    v_cos_f32 v251, v255
    v_sin_f32 v252, v252
    v_sin_f32 v253, v253
    v_mfma_f32_32x32x16_bf16 v[208:223], a[40:43], v[76:79], v[208:223]
    buffer_load_dwordx4 v[36:39], v9, s[36:39], s84 offen offset:2048 sc1
    buffer_load_dword v27, v17, s[36:39], s65 offen sc1
    v_sin_f32 v254, v254
    v_sin_f32 v255, v255
    v_mfma_f32_32x32x16_bf16 v[224:239], a[44:47], v[76:79], v[224:239]
    v_cvt_pk_bf16_f32 v248, v248, v249
    v_cvt_pk_bf16_f32 v249, v250, v251
    v_cvt_pk_bf16_f32 v250, -v252, -v253
    v_cvt_pk_bf16_f32 v251, -v254, -v255
    s_waitcnt vmcnt(19)
    v_mfma_f32_32x32x16_bf16 v[160:175], a[48:51], v[80:83], v[160:175]
    buffer_load_dwordx4 v[40:43], v8, s[36:39], s85 offen offset:2048 sc1
    ds_write_b128 v26, v[248:251] offset:5120
    v_fmamk_f32 v244, v13, 0x42400000, v14
    v_fmamk_f32 v245, v13, 0x42440000, v14
    v_fmamk_f32 v246, v13, 0x42480000, v14
    v_mfma_f32_32x32x16_bf16 v[192:207], a[52:55], v[80:83], v[192:207]
    buffer_load_dwordx4 v[44:47], v9, s[36:39], s85 offen offset:2048 sc1
    v_fmamk_f32 v247, v13, 0x424c0000, v14
    v_cos_f32 v240, v244
    v_cos_f32 v241, v245
    s_waitcnt vmcnt(20)
    v_mfma_f32_32x32x16_bf16 v[208:223], a[48:51], v[84:87], v[208:223]
    v_cos_f32 v242, v246
    v_cos_f32 v243, v247
    v_mfma_f32_32x32x16_bf16 v[224:239], a[52:55], v[84:87], v[224:239]
    buffer_load_dwordx4 a[212:215], v7, s[36:39], s77 offen offset:2048 sc1
    v_sin_f32 v244, v244
    v_sin_f32 v245, v245
    s_waitcnt vmcnt(16)
    v_mfma_f32_32x32x16_bf16 v[160:175], a[56:59], v[88:91], v[160:175]
    buffer_load_dwordx4 a[216:219], v6, s[36:39], s78 offen offset:2048 sc1
    v_sin_f32 v246, v246
    v_sin_f32 v247, v247
    v_cvt_pk_bf16_f32 v240, v240, v241
    v_cvt_pk_bf16_f32 v241, v242, v243
    v_mfma_f32_32x32x16_bf16 v[192:207], a[60:63], v[88:91], v[192:207]
    buffer_load_dwordx4 a[220:223], v7, s[36:39], s78 offen offset:2048 sc1
    v_cvt_pk_bf16_f32 v242, -v244, -v245
    v_cvt_pk_bf16_f32 v243, -v246, -v247
    s_waitcnt vmcnt(17)
    v_mfma_f32_32x32x16_bf16 v[208:223], a[56:59], v[92:95], v[208:223]
    ds_write_b128 v26, v[240:243] offset:6144
    v_fmamk_f32 v252, v13, 0x42600000, v14
    v_fmamk_f32 v253, v13, 0x42640000, v14
    v_fmamk_f32 v254, v13, 0x42680000, v14
    v_fmamk_f32 v255, v13, 0x426c0000, v14
    v_mfma_f32_32x32x16_bf16 v[224:239], a[60:63], v[92:95], v[224:239]
    v_cos_f32 v248, v252
    v_cos_f32 v249, v253
    v_cos_f32 v250, v254
    s_waitcnt vmcnt(16)
    v_mfma_f32_32x32x16_bf16 v[160:175], a[64:67], v[96:99], v[160:175]
    v_cos_f32 v251, v255
    v_sin_f32 v252, v252
    v_mfma_f32_32x32x16_bf16 v[192:207], a[68:71], v[96:99], v[192:207]
    v_sin_f32 v253, v253
    v_sin_f32 v254, v254
    v_sin_f32 v255, v255
    s_waitcnt vmcnt(15)
    v_mfma_f32_32x32x16_bf16 v[208:223], a[64:67], v[100:103], v[208:223]
    v_cvt_pk_bf16_f32 v248, v248, v249
    v_cvt_pk_bf16_f32 v249, v250, v251
    v_cvt_pk_bf16_f32 v250, -v252, -v253
    v_cvt_pk_bf16_f32 v251, -v254, -v255
    v_mfma_f32_32x32x16_bf16 v[224:239], a[68:71], v[100:103], v[224:239]
    ds_write_b128 v26, v[248:251] offset:7168
    v_fmamk_f32 v244, v13, 0x42800000, v14
    v_fmamk_f32 v245, v13, 0x42820000, v14
    v_fmamk_f32 v246, v13, 0x42840000, v14
    v_fmamk_f32 v247, v13, 0x42860000, v14
    s_waitcnt vmcnt(14)
    v_mfma_f32_32x32x16_bf16 v[160:175], a[72:75], v[104:107], v[160:175]
    v_cos_f32 v240, v244
    v_cos_f32 v241, v245
    v_mfma_f32_32x32x16_bf16 v[192:207], a[76:79], v[104:107], v[192:207]
    v_cos_f32 v242, v246
    v_cos_f32 v243, v247
    v_sin_f32 v244, v244
    s_waitcnt vmcnt(13)
    v_mfma_f32_32x32x16_bf16 v[208:223], a[72:75], v[108:111], v[208:223]
    s_waitcnt vmcnt(5)
    v_cmp_eq_u32 vcc, 0, v27
    s_nop 0
    s_cbranch_vccnz L_slow_h2
L_ok_h2:
    s_add_u32 s65, s65, 0x4000
    v_sin_f32 v245, v245
    v_sin_f32 v246, v246
    v_mfma_f32_32x32x16_bf16 v[224:239], a[76:79], v[108:111], v[224:239]
    buffer_load_dwordx4 v[48:51], v11, s[36:39], s79 offen offset:0 sc1
    v_sin_f32 v247, v247
    v_cvt_pk_bf16_f32 v240, v240, v241
    v_cvt_pk_bf16_f32 v241, v242, v243
    v_mfma_f32_32x32x16_bf16 v[160:175], a[80:83], v[112:115], v[160:175]
    buffer_load_dwordx4 v[52:55], v12, s[36:39], s79 offen offset:0 sc1
    v_cvt_pk_bf16_f32 v242, -v244, -v245
    v_cvt_pk_bf16_f32 v243, -v246, -v247
    v_mfma_f32_32x32x16_bf16 v[192:207], a[84:87], v[112:115], v[192:207]
    ds_write_b128 v26, v[240:243] offset:8192
    buffer_load_dwordx4 v[56:59], v11, s[36:39], s80 offen offset:0 sc1
    v_fmamk_f32 v252, v13, 0x42900000, v14
    v_fmamk_f32 v253, v13, 0x42920000, v14
    v_fmamk_f32 v254, v13, 0x42940000, v14
    v_fmamk_f32 v255, v13, 0x42960000, v14
    v_mfma_f32_32x32x16_bf16 v[208:223], a[80:83], v[116:119], v[208:223]
    buffer_load_dword v5, v18, s[36:39], s49 offen sc1
    v_cos_f32 v248, v252
    v_cos_f32 v249, v253
    v_mfma_f32_32x32x16_bf16 v[224:239], a[84:87], v[116:119], v[224:239]
    buffer_load_dwordx4 v[60:63], v12, s[36:39], s80 offen offset:0 sc1
    v_cos_f32 v250, v254
    v_cos_f32 v251, v255
    v_sin_f32 v252, v252
    v_mfma_f32_32x32x16_bf16 v[160:175], a[88:91], v[120:123], v[160:175]
    buffer_load_dwordx4 v[64:67], v11, s[36:39], s81 offen offset:0 sc1
    v_sin_f32 v253, v253
    v_sin_f32 v254, v254
    v_mfma_f32_32x32x16_bf16 v[192:207], a[92:95], v[120:123], v[192:207]
    buffer_load_dwordx4 v[68:71], v12, s[36:39], s81 offen offset:0 sc1
    v_sin_f32 v255, v255
    v_cvt_pk_bf16_f32 v248, v248, v249
    v_cvt_pk_bf16_f32 v249, v250, v251
    v_cvt_pk_bf16_f32 v250, -v252, -v253
    v_mfma_f32_32x32x16_bf16 v[208:223], a[88:91], v[124:127], v[208:223]
    v_cvt_pk_bf16_f32 v251, -v254, -v255
    v_fmamk_f32 v244, v13, 0x42a00000, v14
    v_mfma_f32_32x32x16_bf16 v[224:239], a[92:95], v[124:127], v[224:239]
    ds_write_b128 v26, v[248:251] offset:9216
    buffer_load_dwordx4 v[72:75], v11, s[36:39], s82 offen offset:0 sc1
    v_fmamk_f32 v245, v13, 0x42a20000, v14
    v_fmamk_f32 v246, v13, 0x42a40000, v14
    v_fmamk_f32 v247, v13, 0x42a60000, v14
    v_cos_f32 v240, v244
    v_mfma_f32_32x32x16_bf16 v[160:175], a[96:99], v[32:35], v[160:175]
    buffer_load_dwordx4 v[76:79], v12, s[36:39], s82 offen offset:0 sc1
    v_cos_f32 v241, v245
    v_cos_f32 v242, v246
    v_mfma_f32_32x32x16_bf16 v[192:207], a[100:103], v[32:35], v[192:207]
    v_cos_f32 v243, v247
    v_sin_f32 v244, v244
    v_sin_f32 v245, v245
    v_mfma_f32_32x32x16_bf16 v[208:223], a[96:99], v[36:39], v[208:223]
    buffer_load_dwordx4 v[80:83], v11, s[36:39], s83 offen offset:0 sc1
    v_sin_f32 v246, v246
    v_sin_f32 v247, v247
    v_mfma_f32_32x32x16_bf16 v[224:239], a[100:103], v[36:39], v[224:239]
    buffer_load_dwordx4 v[84:87], v12, s[36:39], s83 offen offset:0 sc1
    v_cvt_pk_bf16_f32 v240, v240, v241
    v_cvt_pk_bf16_f32 v241, v242, v243
    v_cvt_pk_bf16_f32 v242, -v244, -v245
    v_cvt_pk_bf16_f32 v243, -v246, -v247
    s_waitcnt vmcnt(15)
    v_mfma_f32_32x32x16_bf16 v[160:175], a[104:107], v[40:43], v[160:175]
    buffer_load_dwordx4 v[88:91], v11, s[36:39], s84 offen offset:0 sc1
    ds_write_b128 v26, v[240:243] offset:10240
    v_fmamk_f32 v252, v13, 0x42b00000, v14
    v_fmamk_f32 v253, v13, 0x42b20000, v14
    v_fmamk_f32 v254, v13, 0x42b40000, v14
    v_mfma_f32_32x32x16_bf16 v[192:207], a[108:111], v[40:43], v[192:207]
    v_fmamk_f32 v255, v13, 0x42b60000, v14
    v_cos_f32 v248, v252
    v_cos_f32 v249, v253
    s_waitcnt vmcnt(15)
    v_mfma_f32_32x32x16_bf16 v[208:223], a[104:107], v[44:47], v[208:223]
    buffer_load_dwordx4 v[92:95], v12, s[36:39], s84 offen offset:0 sc1
    buffer_load_dword v27, v17, s[36:39], s65 offen sc1
    v_cos_f32 v250, v254
    v_cos_f32 v251, v255
    v_mfma_f32_32x32x16_bf16 v[224:239], a[108:111], v[44:47], v[224:239]
    buffer_load_dwordx4 v[96:99], v11, s[36:39], s85 offen offset:0 sc1
    v_sin_f32 v252, v252
    v_sin_f32 v253, v253
    s_waitcnt vmcnt(14)
    v_mfma_f32_32x32x16_bf16 v[160:175], a[112:115], v[48:51], v[160:175]
    v_sin_f32 v254, v254
    v_sin_f32 v255, v255
    v_cvt_pk_bf16_f32 v248, v248, v249
    v_cvt_pk_bf16_f32 v249, v250, v251
    v_mfma_f32_32x32x16_bf16 v[192:207], a[116:119], v[48:51], v[192:207]
    buffer_load_dwordx4 v[100:103], v12, s[36:39], s85 offen offset:0 sc1
    v_cvt_pk_bf16_f32 v250, -v252, -v253
    v_cvt_pk_bf16_f32 v251, -v254, -v255
    s_waitcnt vmcnt(14)
    v_mfma_f32_32x32x16_bf16 v[208:223], a[112:115], v[52:55], v[208:223]
    s_waitcnt vmcnt(12)
    v_cmp_eq_u32 vcc, 0, v5
    s_nop 0
    s_cbranch_vccnz L_slow_t0
L_ok_t0:
    s_add_u32 s49, s49, 16384
    ds_write_b128 v26, v[248:251] offset:11264
    v_fmamk_f32 v244, v13, 0x42c00000, v14
    v_fmamk_f32 v245, v13, 0x42c20000, v14
    v_mfma_f32_32x32x16_bf16 v[224:239], a[116:119], v[52:55], v[224:239]
    s_add_u32 s62, s68, 0
    s_add_u32 m0, s69, 49152
    s_nop 0
    buffer_load_dwordx4 v1, s[36:39], s62 offen sc1 lds
    v_fmamk_f32 v246, v13, 0x42c40000, v14
    v_fmamk_f32 v247, v13, 0x42c60000, v14
    v_cos_f32 v240, v244
    v_mfma_f32_32x32x16_bf16 v[160:175], a[120:123], v[56:59], v[160:175]
    v_cos_f32 v241, v245
    v_cos_f32 v242, v246
    v_mfma_f32_32x32x16_bf16 v[192:207], a[124:127], v[56:59], v[192:207]
    s_add_u32 s62, s68, 1024
    s_add_u32 m0, s69, 50176
    s_nop 0
    buffer_load_dwordx4 v1, s[36:39], s62 offen sc1 lds
    v_cos_f32 v243, v247
    v_sin_f32 v244, v244
    v_sin_f32 v245, v245
    s_waitcnt vmcnt(13)
    v_mfma_f32_32x32x16_bf16 v[208:223], a[120:123], v[60:63], v[208:223]
    s_add_u32 s62, s68, 2048
    s_add_u32 m0, s69, 51200
    s_nop 0
    buffer_load_dwordx4 v1, s[36:39], s62 offen sc1 lds
    v_sin_f32 v246, v246
    v_sin_f32 v247, v247
    v_mfma_f32_32x32x16_bf16 v[224:239], a[124:127], v[60:63], v[224:239]
    v_cvt_pk_bf16_f32 v240, v240, v241
    v_cvt_pk_bf16_f32 v241, v242, v243
    v_cvt_pk_bf16_f32 v242, -v244, -v245
    v_cvt_pk_bf16_f32 v243, -v246, -v247
    s_waitcnt vmcnt(13)
    v_mfma_f32_32x32x16_bf16 v[160:175], a[128:131], v[64:67], v[160:175]
    ds_write_b128 v26, v[240:243] offset:12288
    v_fmamk_f32 v252, v13, 0x42d00000, v14
    v_fmamk_f32 v253, v13, 0x42d20000, v14
    v_fmamk_f32 v254, v13, 0x42d40000, v14
    v_fmamk_f32 v255, v13, 0x42d60000, v14
    v_cos_f32 v248, v252
    v_cos_f32 v249, v253
    v_cos_f32 v250, v254
    v_cos_f32 v251, v255
    v_sin_f32 v252, v252
    v_sin_f32 v253, v253
    v_sin_f32 v254, v254
    v_sin_f32 v255, v255
    v_mul_f32 v251, v4, v251
    v_cvt_pk_bf16_f32 v248, v248, v249
    v_cvt_pk_bf16_f32 v249, v250, v251
    v_cvt_pk_bf16_f32 v250, -v252, -v253
    v_cvt_pk_bf16_f32 v251, -v254, -v255
    v_mfma_f32_32x32x16_bf16 v[192:207], a[132:135], v[64:67], v[192:207]
    ds_write_b128 v26, v[248:251] offset:13312
    s_add_u32 s62, s68, 3072
    s_add_u32 m0, s69, 52224
    s_nop 0
    buffer_load_dwordx4 v1, s[36:39], s62 offen sc1 lds
    s_waitcnt lgkmcnt(0)
    s_barrier
    s_waitcnt vmcnt(13)
    v_mfma_f32_32x32x16_bf16 v[208:223], a[128:131], v[68:71], v[208:223]
    s_add_u32 s62, s68, 4096
    s_add_u32 m0, s69, 53248
    s_nop 0
    buffer_load_dwordx4 v1, s[36:39], s62 offen sc1 lds
    v_mfma_f32_32x32x16_bf16 v[224:239], a[132:135], v[68:71], v[224:239]
    s_add_u32 s62, s68, 5120
    s_add_u32 m0, s69, 54272
    s_nop 0
    buffer_load_dwordx4 v1, s[36:39], s62 offen sc1 lds
    ds_read_b128 v[240:243], v25
    s_waitcnt vmcnt(14)
    v_mfma_f32_32x32x16_bf16 v[160:175], a[136:139], v[72:75], v[160:175]
    s_add_u32 s62, s68, 6144
    s_add_u32 m0, s69, 55296
    s_nop 0
    buffer_load_dwordx4 v1, s[36:39], s62 offen sc1 lds
    s_waitcnt vmcnt(9)
    v_cmp_eq_u32 vcc, 0, v27
    s_nop 0
    s_cbranch_vccnz L_slow_h3
L_ok_h3:
    s_add_u32 s65, s65, 0x4000
    v_xor_b32 v25, 32, v25
    ds_read_b128 v[244:247], v25
    v_mfma_f32_32x32x16_bf16 v[192:207], a[140:143], v[72:75], v[192:207]
    v_mfma_f32_32x32x16_bf16 v[208:223], a[136:139], v[76:79], v[208:223]
    s_add_u32 s62, s68, 7168
    s_add_u32 m0, s69, 56320
    s_nop 0
    buffer_load_dwordx4 v1, s[36:39], s62 offen sc1 lds
    ds_read_b128 a[0:3], v10 offset:0
    ds_read_b128 a[4:7], v10 offset:1024
    v_mfma_f32_32x32x16_bf16 v[224:239], a[140:143], v[76:79], v[224:239]
    buffer_load_dwordx4 v[104:107], v11, s[36:39], s79 offen offset:2048 sc1
    ds_read_b128 a[8:11], v10 offset:2048
    ds_read_b128 a[12:15], v10 offset:3072
    v_mfma_f32_32x32x16_bf16 v[160:175], a[144:147], v[80:83], v[160:175]
    buffer_load_dwordx4 v[108:111], v12, s[36:39], s79 offen offset:2048 sc1
    ds_read_b128 a[16:19], v10 offset:4096
    ds_read_b128 a[20:23], v10 offset:5120
    v_mfma_f32_32x32x16_bf16 v[192:207], a[148:151], v[80:83], v[192:207]
    buffer_load_dwordx4 v[112:115], v11, s[36:39], s80 offen offset:2048 sc1
    ds_read_b128 a[24:27], v10 offset:6144
    ds_read_b128 a[28:31], v10 offset:7168
    s_waitcnt lgkmcnt(9)
    v_permlane32_swap_b32 v240, v242
    v_mfma_f32_32x32x16_bf16 v[208:223], a[144:147], v[84:87], v[208:223]
    ds_read_b128 a[56:59], v10 offset:14336
    ds_read_b128 a[60:63], v10 offset:15360
    v_permlane32_swap_b32 v241, v243
    v_mfma_f32_32x32x16_bf16 v[224:239], a[148:151], v[84:87], v[224:239]
    buffer_load_dwordx4 v[116:119], v12, s[36:39], s80 offen offset:2048 sc1
    ds_read_b128 a[64:67], v10 offset:16384
    ds_read_b128 a[68:71], v10 offset:17408
    v_mfma_f32_32x32x16_bf16 v[160:175], a[152:155], v[88:91], v[160:175]
    buffer_load_dwordx4 v[120:123], v11, s[36:39], s81 offen offset:2048 sc1
    ds_read_b128 a[72:75], v10 offset:18432
    ds_read_b128 a[76:79], v10 offset:19456
    v_mfma_f32_32x32x16_bf16 v[192:207], a[156:159], v[88:91], v[192:207]
    ds_read_b128 a[80:83], v10 offset:20480
    ds_read_b128 a[84:87], v10 offset:21504
    s_waitcnt lgkmcnt(15)
    v_permlane32_swap_b32 v244, v246
    v_mfma_f32_32x32x16_bf16 v[208:223], a[152:155], v[92:95], v[208:223]
    ds_read_b128 a[32:35], v10 offset:8192
    ds_read_b128 a[36:39], v10 offset:9216
    ds_read_b128 a[40:43], v10 offset:10240
    ds_read_b128 a[44:47], v10 offset:11264
    ds_read_b128 a[48:51], v10 offset:12288
    ds_read_b128 a[52:55], v10 offset:13312
    ds_read_b128 a[88:91], v10 offset:22528
    ds_read_b128 a[92:95], v10 offset:23552
    ds_read_b128 a[96:99], v10 offset:24576
    ds_read_b128 a[100:103], v10 offset:25600
    ds_read_b128 a[104:107], v10 offset:26624
    ds_read_b128 a[108:111], v10 offset:27648
    s_waitcnt vmcnt(5)
    s_waitcnt lgkmcnt(0)
    s_barrier
    v_mfma_f32_32x32x16_bf16 v[224:239], a[156:159], v[92:95], v[224:239]
    buffer_load_dwordx4 v[124:127], v12, s[36:39], s81 offen offset:2048 sc1
    buffer_load_dwordx4 v[32:35], v11, s[36:39], s82 offen offset:2048 sc1
    s_mov_b32 s62, 0
    buffer_load_dwordx4 v[64:67], v1, s[40:43], s62 offen
    buffer_load_dwordx4 v[68:71], v1, s[40:43], s62 offen offset:1024
    v_mfma_f32_32x32x16_bf16 v[160:175], a[160:163], v[96:99], v[160:175]
    ds_read_b128 a[224:227], v23 offset:0
    v_mfma_f32_32x32x16_bf16 v[192:207], a[164:167], v[96:99], v[192:207]
    buffer_load_dwordx4 v[36:39], v12, s[36:39], s82 offen offset:2048 sc1
    ds_read_b128 a[228:231], v19 offset:0
    v_mfma_f32_32x32x16_bf16 v[208:223], a[160:163], v[100:103], v[208:223]
    ds_read_b128 a[232:235], v23 offset:2048
    buffer_load_dwordx4 v[40:43], v11, s[36:39], s83 offen offset:2048 sc1
    v_mfma_f32_32x32x16_bf16 v[224:239], a[164:167], v[100:103], v[224:239]
    ds_read_b128 a[236:239], v19 offset:2048
    buffer_load_dwordx4 v[44:47], v12, s[36:39], s83 offen offset:2048 sc1
    ds_read_b128 a[240:243], v23 offset:4096
    s_waitcnt lgkmcnt(4)
    v_mfma_f32_32x32x16_bf16 v[128:143], a[224:227], a[0:3], 0
    ds_read_b128 a[244:247], v19 offset:4096
    ds_read_b128 a[248:251], v23 offset:6144
    s_waitcnt lgkmcnt(5)
    v_mfma_f32_32x32x16_bf16 v[128:143], a[228:231], a[4:7], v[128:143]
    buffer_load_dwordx4 v[48:51], v11, s[36:39], s84 offen offset:2048 sc1
    ds_read_b128 a[252:255], v19 offset:6144
    ds_read_b128 a[224:227], v23 offset:14336
    s_waitcnt lgkmcnt(6)
    v_mfma_f32_32x32x16_bf16 v[128:143], a[232:235], a[8:11], v[128:143]
    buffer_load_dwordx4 v[52:55], v12, s[36:39], s84 offen offset:2048 sc1
    ds_read_b128 a[228:231], v19 offset:14336
    ds_read_b128 a[232:235], v23 offset:16384
    s_waitcnt lgkmcnt(7)
    v_mfma_f32_32x32x16_bf16 v[128:143], a[236:239], a[12:15], v[128:143]
    buffer_load_dwordx4 v[56:59], v11, s[36:39], s85 offen offset:2048 sc1
    buffer_load_dword v5, v18, s[36:39], s49 offen sc1
    ds_read_b128 a[236:239], v19 offset:16384
    s_waitcnt lgkmcnt(7)
    v_mfma_f32_32x32x16_bf16 v[128:143], a[240:243], a[16:19], v[128:143]
    ds_read_b128 a[240:243], v23 offset:18432
    v_permlane32_swap_b32 v245, v247
    s_waitcnt lgkmcnt(7)
    v_mfma_f32_32x32x16_bf16 v[128:143], a[244:247], a[20:23], v[128:143]
    buffer_load_dwordx4 v[60:63], v12, s[36:39], s85 offen offset:2048 sc1
    ds_read_b128 a[244:247], v19 offset:18432
    s_waitcnt lgkmcnt(7)
    v_mfma_f32_32x32x16_bf16 v[128:143], a[248:251], a[24:27], v[128:143]
    ds_read_b128 a[248:251], v23 offset:20480
    v_lshlrev_b32 v176, 16, v240
    s_waitcnt lgkmcnt(7)
    v_mfma_f32_32x32x16_bf16 v[128:143], a[252:255], a[28:31], v[128:143]
    ds_read_b128 a[252:255], v19 offset:20480
    v_and_b32 v177, s56, v240
    s_waitcnt lgkmcnt(7)
    v_mfma_f32_32x32x16_bf16 v[128:143], a[224:227], a[56:59], v[128:143]
    v_lshlrev_b32 v178, 16, v241
    s_waitcnt lgkmcnt(6)
    v_mfma_f32_32x32x16_bf16 v[128:143], a[228:231], a[60:63], v[128:143]
    v_and_b32 v179, s56, v241
    v_lshlrev_b32 v180, 16, v242
    s_waitcnt lgkmcnt(5)
    v_mfma_f32_32x32x16_bf16 v[128:143], a[232:235], a[64:67], v[128:143]
    v_and_b32 v181, s56, v242
    s_waitcnt lgkmcnt(4)
    v_mfma_f32_32x32x16_bf16 v[128:143], a[236:239], a[68:71], v[128:143]
    v_lshlrev_b32 v182, 16, v243
    s_waitcnt lgkmcnt(3)
    v_mfma_f32_32x32x16_bf16 v[128:143], a[240:243], a[72:75], v[128:143]
    v_and_b32 v183, s56, v243
    v_lshlrev_b32 v184, 16, v244
    s_waitcnt lgkmcnt(2)
    v_mfma_f32_32x32x16_bf16 v[128:143], a[244:247], a[76:79], v[128:143]
    v_and_b32 v185, s56, v244
    s_waitcnt lgkmcnt(1)
    v_mfma_f32_32x32x16_bf16 v[128:143], a[248:251], a[80:83], v[128:143]
    v_lshlrev_b32 v186, 16, v245
    v_and_b32 v187, s56, v245
    s_waitcnt lgkmcnt(0)
    v_mfma_f32_32x32x16_bf16 v[128:143], a[252:255], a[84:87], v[128:143]
    v_lshlrev_b32 v188, 16, v246
    s_waitcnt vmcnt(15)
    v_mfma_f32_32x32x16_bf16 v[224:239], a[172:175], v[108:111], v[224:239]
    v_and_b32 v189, s56, v246
    v_lshlrev_b32 v190, 16, v247
    s_waitcnt vmcnt(13)
    v_mfma_f32_32x32x16_bf16 v[224:239], a[180:183], v[116:119], v[224:239]
    s_waitcnt vmcnt(1)
    v_cmp_eq_u32 vcc, 0, v5
    s_nop 0
    s_cbranch_vccnz L_slow_t1
L_ok_t1:
    s_add_u32 s49, s49, 16384
    v_mfma_f32_32x32x16_bf16 v[224:239], a[188:191], v[124:127], v[224:239]
    s_add_u32 s62, s68, 8192
    s_add_u32 m0, s69, 57344
    s_nop 0
    buffer_load_dwordx4 v1, s[36:39], s62 offen sc1 lds
    v_mfma_f32_32x32x16_bf16 v[224:239], a[196:199], v[36:39], v[224:239]
    s_add_u32 s62, s68, 9216
    s_add_u32 m0, s69, 58368
    s_nop 0
    buffer_load_dwordx4 v1, s[36:39], s62 offen sc1 lds
    v_mfma_f32_32x32x16_bf16 v[224:239], a[204:207], v[44:47], v[224:239]
    s_mov_b32 s70, 0xbfb8aa3b
    v_and_b32 v191, s56, v247
    v_mfma_f32_32x32x16_bf16 v[224:239], a[212:215], v[52:55], v[224:239]
    s_add_u32 s62, s68, 10240
    s_add_u32 m0, s69, 59392
    s_nop 0
    buffer_load_dwordx4 v1, s[36:39], s62 offen sc1 lds
    v_mov_b32 v20, 0xbfb8aa3b
    s_waitcnt vmcnt(3)
    v_mfma_f32_32x32x16_bf16 v[224:239], a[220:223], v[60:63], v[224:239]
    s_add_u32 s62, s68, 11264
    s_add_u32 m0, s69, 60416
    s_nop 0
    buffer_load_dwordx4 v1, s[36:39], s62 offen sc1 lds
    v_mfma_f32_32x32x16_bf16 v[208:223], a[168:171], v[108:111], v[208:223]
    s_add_u32 s62, s68, 12288
    s_add_u32 m0, s69, 61440
    s_nop 0
    buffer_load_dwordx4 v1, s[36:39], s62 offen sc1 lds
    v_mov_b32 v21, 1.0
    v_mfma_f32_32x32x16_bf16 v[208:223], a[176:179], v[116:119], v[208:223]
    v_mfma_f32_32x32x16_bf16 v[208:223], a[184:187], v[124:127], v[208:223]
    s_add_u32 s62, s68, 13312
    s_add_u32 m0, s69, 62464
    s_nop 0
    buffer_load_dwordx4 v1, s[36:39], s62 offen sc1 lds
    v_mfma_f32_32x32x16_bf16 v[208:223], a[192:195], v[36:39], v[208:223]
    ds_write_b128 v30, v[224:227] offset:0
    v_mfma_f32_32x32x16_bf16 v[208:223], a[200:203], v[44:47], v[208:223]
    ds_write_b128 v30, v[228:231] offset:1024
    v_mfma_f32_32x32x16_bf16 v[208:223], a[208:211], v[52:55], v[208:223]
    ds_write_b128 v30, v[232:235] offset:2048
    v_mfma_f32_32x32x16_bf16 v[208:223], a[216:219], v[60:63], v[208:223]
    v_mfma_f32_32x32x16_bf16 v[192:207], a[172:175], v[104:107], v[192:207]
    ds_write_b128 v30, v[236:239] offset:3072
    v_mfma_f32_32x32x16_bf16 v[192:207], a[180:183], v[112:115], v[192:207]
    v_mfma_f32_32x32x16_bf16 v[192:207], a[188:191], v[120:123], v[192:207]
    s_waitcnt vmcnt(0)
    s_barrier
    ds_read_b128 a[224:227], v23 offset:8192
    ds_read_b128 a[228:231], v19 offset:8192
    v_mfma_f32_32x32x16_bf16 v[192:207], a[196:199], v[32:35], v[192:207]
    ds_read_b128 a[232:235], v23 offset:10240
    ds_read_b128 a[236:239], v19 offset:10240
    v_mfma_f32_32x32x16_bf16 v[192:207], a[204:207], v[40:43], v[192:207]
    ds_read_b128 a[240:243], v23 offset:12288
    ds_read_b128 a[244:247], v19 offset:12288
    v_mfma_f32_32x32x16_bf16 v[192:207], a[212:215], v[48:51], v[192:207]
    ds_write_b128 v29, v[208:211] offset:0
    ds_read_b128 a[248:251], v23 offset:22528
    v_mfma_f32_32x32x16_bf16 v[192:207], a[220:223], v[56:59], v[192:207]
    ds_write_b128 v29, v[212:215] offset:1024
    s_waitcnt lgkmcnt(8)
    v_mfma_f32_32x32x16_bf16 v[128:143], a[224:227], a[32:35], v[128:143]
    ds_write_b128 v29, v[216:219] offset:2048
    s_waitcnt lgkmcnt(8)
    v_mfma_f32_32x32x16_bf16 v[128:143], a[228:231], a[36:39], v[128:143]
    ds_write_b128 v29, v[220:223] offset:3072
    s_waitcnt lgkmcnt(8)
    v_mfma_f32_32x32x16_bf16 v[128:143], a[232:235], a[40:43], v[128:143]
    ds_read_b128 a[252:255], v19 offset:22528
    s_waitcnt lgkmcnt(8)
    v_mfma_f32_32x32x16_bf16 v[128:143], a[236:239], a[44:47], v[128:143]
    ds_read_b128 a[224:227], v23 offset:24576
    ds_read_b128 a[228:231], v19 offset:24576
    s_waitcnt lgkmcnt(9)
    v_mfma_f32_32x32x16_bf16 v[128:143], a[240:243], a[48:51], v[128:143]
    ds_read_b128 a[232:235], v23 offset:26624
    ds_read_b128 a[236:239], v19 offset:26624
    s_waitcnt lgkmcnt(10)
    v_mfma_f32_32x32x16_bf16 v[128:143], a[244:247], a[52:55], v[128:143]
    ds_write_b128 v28, v[192:195] offset:0
    s_waitcnt lgkmcnt(9)
    v_mfma_f32_32x32x16_bf16 v[128:143], a[248:251], a[88:91], v[128:143]
    ds_write_b128 v28, v[196:199] offset:1024
    s_waitcnt lgkmcnt(6)
    v_mfma_f32_32x32x16_bf16 v[128:143], a[252:255], a[92:95], v[128:143]
    ds_write_b128 v28, v[200:203] offset:2048
    s_waitcnt lgkmcnt(6)
    v_mfma_f32_32x32x16_bf16 v[128:143], a[224:227], a[96:99], v[128:143]
    ds_write_b128 v28, v[204:207] offset:3072
    s_waitcnt lgkmcnt(6)
    v_mfma_f32_32x32x16_bf16 v[128:143], a[228:231], a[100:103], v[128:143]
    s_waitcnt lgkmcnt(5)
    v_mfma_f32_32x32x16_bf16 v[128:143], a[232:235], a[104:107], v[128:143]
    s_waitcnt lgkmcnt(0)
    s_barrier
    v_mfma_f32_32x32x16_bf16 v[128:143], a[236:239], a[108:111], v[128:143]
    ds_read_b128 v[192:195], v31 offset:0
    ds_read_b128 v[196:199], v31 offset:1024
    v_mfma_f32_32x32x16_bf16 v[160:175], a[168:171], v[104:107], v[160:175]
    ds_read_b128 v[200:203], v31 offset:2048
    ds_read_b128 v[204:207], v31 offset:3072
    v_mfma_f32_32x32x16_bf16 v[160:175], a[176:179], v[112:115], v[160:175]
    ds_read_b128 v[208:211], v31 offset:4096
    ds_read_b128 v[212:215], v31 offset:5120
    v_mfma_f32_32x32x16_bf16 v[160:175], a[184:187], v[120:123], v[160:175]
    ds_read_b128 v[216:219], v31 offset:6144
    ds_read_b128 v[220:223], v31 offset:7168
    ds_read_b128 v[224:227], v31 offset:8192
    ds_read_b128 v[228:231], v31 offset:9216
    ds_read_b128 v[232:235], v31 offset:10240
    ds_read_b128 v[236:239], v31 offset:11264
    v_cvt_pk_bf16_f32 v248, v128, v129
    v_cvt_pk_bf16_f32 v249, v130, v131
    v_cvt_pk_bf16_f32 v250, v132, v133
    v_cvt_pk_bf16_f32 v251, v134, v135
    v_mfma_f32_32x32x16_bf16 v[160:175], a[192:195], v[32:35], v[160:175]
    v_cvt_pk_bf16_f32 v252, v136, v137
    v_cvt_pk_bf16_f32 v253, v138, v139
    v_cvt_pk_bf16_f32 v254, v140, v141
    v_cvt_pk_bf16_f32 v255, v142, v143
    s_waitcnt lgkmcnt(7)
    v_add_f32 v192, v192, v208
    v_mfma_f32_32x32x16_bf16 v[160:175], a[200:203], v[40:43], v[160:175]
    v_add_f32 v193, v193, v209
    v_add_f32 v194, v194, v210
    v_add_f32 v195, v195, v211
    s_waitcnt lgkmcnt(6)
    v_add_f32 v196, v196, v212
    v_add_f32 v197, v197, v213
    v_mfma_f32_32x32x16_bf16 v[144:159], v[248:251], v[64:67], 0
    v_add_f32 v198, v198, v214
    v_add_f32 v199, v199, v215
    s_waitcnt lgkmcnt(5)
    v_add_f32 v200, v200, v216
    v_add_f32 v201, v201, v217
    v_add_f32 v202, v202, v218
    v_mfma_f32_32x32x16_bf16 v[144:159], v[252:255], v[68:71], v[144:159]
    v_add_f32 v203, v203, v219
    s_waitcnt lgkmcnt(4)
    v_add_f32 v204, v204, v220
    v_add_f32 v205, v205, v221
    v_add_f32 v206, v206, v222
    v_add_f32 v207, v207, v223
    v_mfma_f32_32x32x16_bf16 v[160:175], a[208:211], v[48:51], v[160:175]
    s_waitcnt lgkmcnt(3)
    v_add_f32 v192, v192, v224
    v_add_f32 v193, v193, v225
    v_add_f32 v194, v194, v226
    v_add_f32 v195, v195, v227
    s_waitcnt lgkmcnt(2)
    v_add_f32 v196, v196, v228
    v_mfma_f32_32x32x16_bf16 v[160:175], a[216:219], v[56:59], v[160:175]
    v_add_f32 v197, v197, v229
    v_add_f32 v198, v198, v230
    v_add_f32 v199, v199, v231
    s_waitcnt lgkmcnt(1)
    v_add_f32 v200, v200, v232
    v_add_f32 v201, v201, v233
    v_add_f32 v202, v202, v234
    v_add_f32 v203, v203, v235
    s_waitcnt lgkmcnt(0)
    v_add_f32 v204, v204, v236
    v_add_f32 v205, v205, v237
    v_add_f32 v206, v206, v238
    v_add_f32 v207, v207, v239
    v_pk_add_f32 v[160:161], v[160:161], v[192:193]
    v_pk_add_f32 v[162:163], v[162:163], v[194:195]
    v_pk_add_f32 v[164:165], v[164:165], v[196:197]
    v_pk_add_f32 v[166:167], v[166:167], v[198:199]
    v_pk_mul_f32 v[192:193], v[160:161], v[20:21] op_sel_hi:[1,0]
    v_pk_mul_f32 v[194:195], v[162:163], v[20:21] op_sel_hi:[1,0]
    v_pk_mul_f32 v[196:197], v[164:165], v[20:21] op_sel_hi:[1,0]
    v_pk_mul_f32 v[198:199], v[166:167], v[20:21] op_sel_hi:[1,0]
    v_exp_f32 v192, v192
    v_exp_f32 v193, v193
    v_exp_f32 v194, v194
    v_exp_f32 v195, v195
    v_exp_f32 v196, v196
    v_exp_f32 v197, v197
    v_exp_f32 v198, v198
    v_exp_f32 v199, v199
    v_pk_mul_f32 v[160:161], v[160:161], v[144:145]
    v_pk_mul_f32 v[162:163], v[162:163], v[146:147]
    v_pk_mul_f32 v[164:165], v[164:165], v[148:149]
    v_pk_mul_f32 v[166:167], v[166:167], v[150:151]
    v_pk_add_f32 v[192:193], v[192:193], v[20:21] op_sel:[0,1] op_sel_hi:[1,1]
    v_pk_add_f32 v[194:195], v[194:195], v[20:21] op_sel:[0,1] op_sel_hi:[1,1]
    v_pk_add_f32 v[196:197], v[196:197], v[20:21] op_sel:[0,1] op_sel_hi:[1,1]
    v_pk_add_f32 v[198:199], v[198:199], v[20:21] op_sel:[0,1] op_sel_hi:[1,1]
    v_rcp_f32 v192, v192
    v_rcp_f32 v193, v193
    v_rcp_f32 v194, v194
    v_rcp_f32 v195, v195
    v_rcp_f32 v196, v196
    v_rcp_f32 v197, v197
    v_rcp_f32 v198, v198
    v_rcp_f32 v199, v199
    v_pk_fma_f32 v[160:161], v[160:161], v[192:193], v[176:177]
    v_pk_fma_f32 v[162:163], v[162:163], v[194:195], v[178:179]
    v_pk_fma_f32 v[164:165], v[164:165], v[196:197], v[180:181]
    v_pk_fma_f32 v[166:167], v[166:167], v[198:199], v[182:183]
    v_cvt_pk_bf16_f32 v248, v160, v161
    v_cvt_pk_bf16_f32 v249, v162, v163
    v_cvt_pk_bf16_f32 v250, v164, v165
    v_cvt_pk_bf16_f32 v251, v166, v167
    s_nop 0
    v_permlane32_swap_b32 v248, v250
    v_permlane32_swap_b32 v249, v251
    v_pk_add_f32 v[168:169], v[168:169], v[200:201]
    v_pk_add_f32 v[170:171], v[170:171], v[202:203]
    v_pk_add_f32 v[172:173], v[172:173], v[204:205]
    v_pk_add_f32 v[174:175], v[174:175], v[206:207]
    v_pk_mul_f32 v[200:201], v[168:169], v[20:21] op_sel_hi:[1,0]
    v_pk_mul_f32 v[202:203], v[170:171], v[20:21] op_sel_hi:[1,0]
    v_pk_mul_f32 v[204:205], v[172:173], v[20:21] op_sel_hi:[1,0]
    v_pk_mul_f32 v[206:207], v[174:175], v[20:21] op_sel_hi:[1,0]
    v_exp_f32 v200, v200
    v_exp_f32 v201, v201
    v_exp_f32 v202, v202
    v_exp_f32 v203, v203
    v_exp_f32 v204, v204
    v_exp_f32 v205, v205
    v_exp_f32 v206, v206
    v_exp_f32 v207, v207
    v_pk_mul_f32 v[168:169], v[168:169], v[152:153]
    v_pk_mul_f32 v[170:171], v[170:171], v[154:155]
    v_pk_mul_f32 v[172:173], v[172:173], v[156:157]
    v_pk_mul_f32 v[174:175], v[174:175], v[158:159]
    v_pk_add_f32 v[200:201], v[200:201], v[20:21] op_sel:[0,1] op_sel_hi:[1,1]
    v_pk_add_f32 v[202:203], v[202:203], v[20:21] op_sel:[0,1] op_sel_hi:[1,1]
    v_pk_add_f32 v[204:205], v[204:205], v[20:21] op_sel:[0,1] op_sel_hi:[1,1]
    v_pk_add_f32 v[206:207], v[206:207], v[20:21] op_sel:[0,1] op_sel_hi:[1,1]
    v_rcp_f32 v200, v200
    v_rcp_f32 v201, v201
    v_rcp_f32 v202, v202
    v_rcp_f32 v203, v203
    v_rcp_f32 v204, v204
    v_rcp_f32 v205, v205
    v_rcp_f32 v206, v206
    v_rcp_f32 v207, v207
    v_pk_fma_f32 v[168:169], v[168:169], v[200:201], v[184:185]
    v_pk_fma_f32 v[170:171], v[170:171], v[202:203], v[186:187]
    v_pk_fma_f32 v[172:173], v[172:173], v[204:205], v[188:189]
    v_pk_fma_f32 v[174:175], v[174:175], v[206:207], v[190:191]
    v_cvt_pk_bf16_f32 v252, v168, v169
    v_cvt_pk_bf16_f32 v253, v170, v171
    v_cvt_pk_bf16_f32 v254, v172, v173
    v_cvt_pk_bf16_f32 v255, v174, v175
    s_nop 0
    v_permlane32_swap_b32 v252, v254
    v_permlane32_swap_b32 v253, v255
    v_add_u32 v25, 106496, v25
    ds_write_b128 v25, v[252:255]
    v_xor_b32 v25, 32, v25
    ds_write_b128 v25, v[248:251]
    s_lshl_b32 s63, s48, 11
    s_add_u32 s63, s63, 106496
    v_add_u32 v25, s63, v1
    s_add_u32 s62, s52, 458752
    s_waitcnt lgkmcnt(0)
    s_barrier
    ds_read_b128 v[248:251], v25
    ds_read_b128 v[252:255], v25 offset:1024
    s_waitcnt lgkmcnt(0)
    buffer_store_dwordx4 v[252:255], v24, s[32:35], s62 offen sc1
    v_xor_b32 v24, 64, v24
    buffer_store_dwordx4 v[248:251], v24, s[32:35], s52 offen sc1
L_end:
    s_endpgm
L_aux:
    s_mov_b32 s14, 1605632
    s_mov_b32 s15, 0x20000
    s_mov_b32 s18, 1605632
    s_mov_b32 s19, 0x20000
    s_mov_b32 s26, 921600
    s_mov_b32 s27, 0x20000
    s_mov_b32 s30, 921600
    s_mov_b32 s31, 0x20000
    s_mov_b32 s38, 12910592
    s_mov_b32 s39, 0x20000
    s_mov_b32 s46, 256
    s_mov_b32 s47, 0x20000
    s_getpc_b64 s[72:73]
    s_add_u32 s72, s72, recurrent_scan__spectral_gfnet__glu_gated_swiglu__prompt_kernel@rel32@lo+4
    s_addc_u32 s73, s73, recurrent_scan__spectral_gfnet__glu_gated_swiglu__prompt_kernel@rel32@hi+12
    s_mov_b32 s74, L_code_end-recurrent_scan__spectral_gfnet__glu_gated_swiglu__prompt_kernel
    s_mov_b32 s75, 0x20000
    s_lshr_b32 s60, s2, 3
    s_lshl_b32 s60, s60, 2
    s_add_u32 s60, s60, s48
    s_lshl_b32 s60, s60, 12
    v_and_b32 v2, 31, v0
    v_lshlrev_b32 v2, 7, v2
    buffer_load_dword v31, v2, s[72:75], s60 offen
    s_and_b32 s51, s2, 15
    s_lshr_b32 s52, s2, 4
    v_mov_b32 v14, 0
    v_mov_b32 v15, 1
    s_lshl_b32 s68, s2, 2
    s_add_u32 s68, s68, s48
    s_sub_u32 s70, 32, s51
    s_cmp_eq_u32 s51, 0
    s_cselect_b32 s70, 16, s70
    s_cselect_b64 s[66:67], -1, 0
    s_and_b32 s60, s48, 1
    s_cmp_eq_u32 s60, 0
    s_cselect_b32 s71, s51, s70
    s_mul_i32 s4, s71, 450
    s_mul_i32 s60, s52, 224
    s_add_u32 s4, s4, s60
    s_add_u32 s4, s4, 2
    s_and_b32 s5, s4, 15
    s_sub_u32 s4, s4, s5
    s_lshr_b32 s60, s48, 1
    s_mul_i32 s60, s60, 460800
    s_add_u32 s4, s4, s60
    s_lshl_b32 s64, s48, 14
    s_add_u32 s64, s64, 65536
    v_lshrrev_b32 v26, 4, v0
    v_and_b32 v25, 15, v0
    v_lshlrev_b32 v24, 1, v26
    v_xor_b32 v24, v24, v25
    v_mul_u32_u24 v2, 57600, v26
    v_lshl_add_u32 v2, v24, 4, v2
    s_cmp_lt_u32 s2, 28
    s_waitcnt lgkmcnt(0)
    s_cbranch_scc1 L_nozero
    v_mov_b32 v8, 0
    v_mov_b32 v9, 0
    v_mov_b32 v10, 0
    v_mov_b32 v11, 0
    s_sub_u32 s60, s68, 112
    s_mul_i32 s60, s60, 6144
    s_add_u32 s60, s60, 12648448
    s_add_u32 s61, s60, 4096
    buffer_store_dwordx4 v[8:11], v1, s[36:39], s60 offen offset:0 sc1
    buffer_store_dwordx4 v[8:11], v1, s[36:39], s60 offen offset:1024 sc1
    buffer_store_dwordx4 v[8:11], v1, s[36:39], s60 offen offset:2048 sc1
    buffer_store_dwordx4 v[8:11], v1, s[36:39], s60 offen offset:3072 sc1
    buffer_store_dwordx4 v[8:11], v1, s[36:39], s61 offen offset:0 sc1
    buffer_store_dwordx4 v[8:11], v1, s[36:39], s61 offen offset:1024 sc1
    s_sub_u32 s60, s68, 112
    s_lshl_b32 s60, s60, 2
    s_waitcnt vmcnt(0)
    s_mov_b64 exec, 1
    buffer_store_dword v15, v14, s[44:47], s60 offen offset:128 sc1
    s_mov_b64 exec, -1
L_nozero:
    v_min_u32 v11, 48, v0
    s_mul_i32 s60, s68, 49
    v_add_u32 v11, s60, v11
    v_lshlrev_b32 v11, 8, v11
    buffer_load_dword v30, v11, s[12:15], 0 offen offset:128
    buffer_load_dword v30, v11, s[16:19], 0 offen offset:128
    s_add_u32 s62, s4, 0
    s_add_u32 m0, s64, 0
    s_nop 0
    buffer_load_dwordx4 v2, s[24:27], s62 offen  lds
    s_add_u32 s62, s4, 14400
    s_add_u32 m0, s64, 1024
    s_nop 0
    buffer_load_dwordx4 v2, s[24:27], s62 offen  lds
    s_add_u32 s62, s4, 28800
    s_add_u32 m0, s64, 2048
    s_nop 0
    buffer_load_dwordx4 v2, s[24:27], s62 offen  lds
    s_add_u32 s62, s4, 43200
    s_add_u32 m0, s64, 3072
    s_nop 0
    buffer_load_dwordx4 v2, s[24:27], s62 offen  lds
    s_lshl_b32 s60, s48, 4
    v_add_u32 v3, s60, v25
    v_lshlrev_b32 v4, 7, v26
    v_add_u32 v6, s70, v4
    v_add_u32 v4, s51, v4
    v_mul_u32_u24 v4, v4, v3
    v_mul_u32_u24 v6, v6, v3
    v_cvt_f32_u32 v4, v4
    v_cvt_f32_u32 v6, v6
    v_cvt_f32_u32 v3, v3
    v_mul_f32 v4, 0x3a000000, v4
    v_mul_f32 v6, 0x3a000000, v6
    v_mul_f32 v3, 0x3c800000, v3
    s_mov_b32 s50, 0x36124925
    v_fmamk_f32 v7, v3, 0x0, v4
    v_fmamk_f32 v8, v3, 0x3f800000, v4
    v_cos_f32 v9, v7
    v_cos_f32 v10, v8
    v_sin_f32 v7, v7
    v_sin_f32 v8, v8
    v_mul_f32 v9, s50, v9
    v_mul_f32 v10, s50, v10
    v_mul_f32 v7, s50, v7
    v_mul_f32 v8, s50, v8
    v_cvt_pk_bf16_f32 v9, v9, v10
    v_cvt_pk_bf16_f32 v10, v7, v8
    v_cvt_pk_bf16_f32 v7, -v7, -v8
    v_accvgpr_write_b32 a48, v9
    v_accvgpr_write_b32 a64, v10
    v_accvgpr_write_b32 a80, v7
    v_fmamk_f32 v7, v3, 0x40000000, v4
    v_fmamk_f32 v8, v3, 0x40400000, v4
    v_cos_f32 v9, v7
    v_cos_f32 v10, v8
    v_sin_f32 v7, v7
    v_sin_f32 v8, v8
    v_mul_f32 v9, s50, v9
    v_mul_f32 v10, s50, v10
    v_mul_f32 v7, s50, v7
    v_mul_f32 v8, s50, v8
    v_cvt_pk_bf16_f32 v9, v9, v10
    v_cvt_pk_bf16_f32 v10, v7, v8
    v_cvt_pk_bf16_f32 v7, -v7, -v8
    v_accvgpr_write_b32 a49, v9
    v_accvgpr_write_b32 a65, v10
    s_add_u32 s62, s4, 230400
    s_add_u32 m0, s64, 4096
    s_nop 0
    buffer_load_dwordx4 v2, s[24:27], s62 offen  lds
    v_accvgpr_write_b32 a81, v7
    v_fmamk_f32 v7, v3, 0x41800000, v4
    v_fmamk_f32 v8, v3, 0x41880000, v4
    v_cos_f32 v9, v7
    v_cos_f32 v10, v8
    v_sin_f32 v7, v7
    v_sin_f32 v8, v8
    v_mul_f32 v9, s50, v9
    v_mul_f32 v10, s50, v10
    v_mul_f32 v7, s50, v7
    v_mul_f32 v8, s50, v8
    v_cvt_pk_bf16_f32 v9, v9, v10
    v_cvt_pk_bf16_f32 v10, v7, v8
    v_cvt_pk_bf16_f32 v7, -v7, -v8
    v_accvgpr_write_b32 a50, v9
    v_accvgpr_write_b32 a66, v10
    v_accvgpr_write_b32 a82, v7
    v_fmamk_f32 v7, v3, 0x41900000, v4
    v_fmamk_f32 v8, v3, 0x41980000, v4
    v_cos_f32 v9, v7
    v_cos_f32 v10, v8
    v_sin_f32 v7, v7
    v_sin_f32 v8, v8
    v_mul_f32 v9, s50, v9
    v_mul_f32 v10, s50, v10
    v_mul_f32 v7, s50, v7
    v_mul_f32 v8, s50, v8
    v_cvt_pk_bf16_f32 v9, v9, v10
    v_cvt_pk_bf16_f32 v10, v7, v8
    v_cvt_pk_bf16_f32 v7, -v7, -v8
    v_accvgpr_write_b32 a51, v9
    v_accvgpr_write_b32 a67, v10
    v_accvgpr_write_b32 a83, v7
    v_fmamk_f32 v7, v3, 0x42000000, v4
    v_fmamk_f32 v8, v3, 0x42040000, v4
    v_cos_f32 v9, v7
    v_cos_f32 v10, v8
    v_sin_f32 v7, v7
    v_sin_f32 v8, v8
    v_mul_f32 v9, s50, v9
    v_mul_f32 v10, s50, v10
    v_mul_f32 v7, s50, v7
    v_mul_f32 v8, s50, v8
    v_cvt_pk_bf16_f32 v9, v9, v10
    v_cvt_pk_bf16_f32 v10, v7, v8
    s_add_u32 s62, s4, 244800
    s_add_u32 m0, s64, 5120
    s_nop 0
    buffer_load_dwordx4 v2, s[24:27], s62 offen  lds
    v_cvt_pk_bf16_f32 v7, -v7, -v8
    v_accvgpr_write_b32 a52, v9
    v_accvgpr_write_b32 a68, v10
    v_accvgpr_write_b32 a84, v7
    v_fmamk_f32 v7, v3, 0x42080000, v4
    v_fmamk_f32 v8, v3, 0x420c0000, v4
    v_cos_f32 v9, v7
    v_cos_f32 v10, v8
    v_sin_f32 v7, v7
    v_sin_f32 v8, v8
    v_mul_f32 v9, s50, v9
    v_mul_f32 v10, s50, v10
    v_mul_f32 v7, s50, v7
    v_mul_f32 v8, s50, v8
    v_cvt_pk_bf16_f32 v9, v9, v10
    v_cvt_pk_bf16_f32 v10, v7, v8
    v_cvt_pk_bf16_f32 v7, -v7, -v8
    v_accvgpr_write_b32 a53, v9
    v_accvgpr_write_b32 a69, v10
    v_accvgpr_write_b32 a85, v7
    v_fmamk_f32 v7, v3, 0x42400000, v4
    v_fmamk_f32 v8, v3, 0x42440000, v4
    v_cos_f32 v9, v7
    v_cos_f32 v10, v8
    v_sin_f32 v7, v7
    v_sin_f32 v8, v8
    v_mul_f32 v9, s50, v9
    v_mul_f32 v10, s50, v10
    v_mul_f32 v7, s50, v7
    v_mul_f32 v8, s50, v8
    v_cvt_pk_bf16_f32 v9, v9, v10
    v_cvt_pk_bf16_f32 v10, v7, v8
    v_cvt_pk_bf16_f32 v7, -v7, -v8
    v_accvgpr_write_b32 a54, v9
    v_accvgpr_write_b32 a70, v10
    v_accvgpr_write_b32 a86, v7
    v_fmamk_f32 v7, v3, 0x42480000, v4
    v_fmamk_f32 v8, v3, 0x424c0000, v4
    v_cos_f32 v9, v7
    v_cos_f32 v10, v8
    v_sin_f32 v7, v7
    v_sin_f32 v8, v8
    v_mul_f32 v9, s50, v9
    v_mul_f32 v10, s50, v10
    v_mul_f32 v7, s50, v7
    s_add_u32 s62, s4, 259200
    s_add_u32 m0, s64, 6144
    s_nop 0
    buffer_load_dwordx4 v2, s[24:27], s62 offen  lds
    v_mul_f32 v8, s50, v8
    v_cvt_pk_bf16_f32 v9, v9, v10
    v_cvt_pk_bf16_f32 v10, v7, v8
    v_cvt_pk_bf16_f32 v7, -v7, -v8
    v_accvgpr_write_b32 a55, v9
    v_accvgpr_write_b32 a71, v10
    v_accvgpr_write_b32 a87, v7
    v_fmamk_f32 v7, v3, 0x0, v6
    v_fmamk_f32 v8, v3, 0x3f800000, v6
    v_cos_f32 v9, v7
    v_cos_f32 v10, v8
    v_sin_f32 v7, v7
    v_sin_f32 v8, v8
    v_mul_f32 v9, s50, v9
    v_mul_f32 v10, s50, v10
    v_mul_f32 v7, s50, v7
    v_mul_f32 v8, s50, v8
    v_cvt_pk_bf16_f32 v9, v9, v10
    v_cvt_pk_bf16_f32 v10, v7, v8
    v_cvt_pk_bf16_f32 v7, -v7, -v8
    v_accvgpr_write_b32 a56, v9
    v_accvgpr_write_b32 a72, v10
    v_accvgpr_write_b32 a88, v7
    v_fmamk_f32 v7, v3, 0x40000000, v6
    v_fmamk_f32 v8, v3, 0x40400000, v6
    v_cos_f32 v9, v7
    v_cos_f32 v10, v8
    v_sin_f32 v7, v7
    v_sin_f32 v8, v8
    v_mul_f32 v9, s50, v9
    v_mul_f32 v10, s50, v10
    v_mul_f32 v7, s50, v7
    v_mul_f32 v8, s50, v8
    v_cvt_pk_bf16_f32 v9, v9, v10
    v_cvt_pk_bf16_f32 v10, v7, v8
    v_cvt_pk_bf16_f32 v7, -v7, -v8
    v_accvgpr_write_b32 a57, v9
    v_accvgpr_write_b32 a73, v10
    v_accvgpr_write_b32 a89, v7
    v_fmamk_f32 v7, v3, 0x41800000, v6
    v_fmamk_f32 v8, v3, 0x41880000, v6
    v_cos_f32 v9, v7
    v_cos_f32 v10, v8
    v_sin_f32 v7, v7
    v_sin_f32 v8, v8
    s_add_u32 s62, s4, 273600
    s_add_u32 m0, s64, 7168
    s_nop 0
    buffer_load_dwordx4 v2, s[24:27], s62 offen  lds
    v_mul_f32 v9, s50, v9
    v_mul_f32 v10, s50, v10
    v_mul_f32 v7, s50, v7
    v_mul_f32 v8, s50, v8
    v_cvt_pk_bf16_f32 v9, v9, v10
    v_cvt_pk_bf16_f32 v10, v7, v8
    v_cvt_pk_bf16_f32 v7, -v7, -v8
    v_accvgpr_write_b32 a58, v9
    v_accvgpr_write_b32 a74, v10
    v_accvgpr_write_b32 a90, v7
    v_fmamk_f32 v7, v3, 0x41900000, v6
    v_fmamk_f32 v8, v3, 0x41980000, v6
    v_cos_f32 v9, v7
    v_cos_f32 v10, v8
    v_sin_f32 v7, v7
    v_sin_f32 v8, v8
    v_mul_f32 v9, s50, v9
    v_mul_f32 v10, s50, v10
    v_mul_f32 v7, s50, v7
    v_mul_f32 v8, s50, v8
    v_cvt_pk_bf16_f32 v9, v9, v10
    v_cvt_pk_bf16_f32 v10, v7, v8
    v_cvt_pk_bf16_f32 v7, -v7, -v8
    v_accvgpr_write_b32 a59, v9
    v_accvgpr_write_b32 a75, v10
    v_accvgpr_write_b32 a91, v7
    v_fmamk_f32 v7, v3, 0x42000000, v6
    v_fmamk_f32 v8, v3, 0x42040000, v6
    v_cos_f32 v9, v7
    v_cos_f32 v10, v8
    v_sin_f32 v7, v7
    v_sin_f32 v8, v8
    v_mul_f32 v9, s50, v9
    v_mul_f32 v10, s50, v10
    v_mul_f32 v7, s50, v7
    v_mul_f32 v8, s50, v8
    v_cvt_pk_bf16_f32 v9, v9, v10
    v_cvt_pk_bf16_f32 v10, v7, v8
    v_cvt_pk_bf16_f32 v7, -v7, -v8
    v_accvgpr_write_b32 a60, v9
    v_accvgpr_write_b32 a76, v10
    v_accvgpr_write_b32 a92, v7
    v_fmamk_f32 v7, v3, 0x42080000, v6
    v_fmamk_f32 v8, v3, 0x420c0000, v6
    v_cos_f32 v9, v7
    s_add_u32 s62, s4, 0
    s_add_u32 m0, s64, 8192
    s_nop 0
    buffer_load_dwordx4 v2, s[28:31], s62 offen  lds
    v_cos_f32 v10, v8
    v_sin_f32 v7, v7
    v_sin_f32 v8, v8
    v_mul_f32 v9, s50, v9
    v_mul_f32 v10, s50, v10
    v_mul_f32 v7, s50, v7
    v_mul_f32 v8, s50, v8
    v_cvt_pk_bf16_f32 v9, v9, v10
    v_cvt_pk_bf16_f32 v10, v7, v8
    v_cvt_pk_bf16_f32 v7, -v7, -v8
    v_accvgpr_write_b32 a61, v9
    v_accvgpr_write_b32 a77, v10
    v_accvgpr_write_b32 a93, v7
    v_fmamk_f32 v7, v3, 0x42400000, v6
    v_fmamk_f32 v8, v3, 0x42440000, v6
    v_cos_f32 v9, v7
    v_cos_f32 v10, v8
    v_sin_f32 v7, v7
    v_sin_f32 v8, v8
    v_mul_f32 v9, s50, v9
    v_mul_f32 v10, s50, v10
    v_mul_f32 v7, s50, v7
    v_mul_f32 v8, s50, v8
    v_cvt_pk_bf16_f32 v9, v9, v10
    v_cvt_pk_bf16_f32 v10, v7, v8
    v_cvt_pk_bf16_f32 v7, -v7, -v8
    v_accvgpr_write_b32 a62, v9
    v_accvgpr_write_b32 a78, v10
    v_accvgpr_write_b32 a94, v7
    v_fmamk_f32 v7, v3, 0x42480000, v6
    v_fmamk_f32 v8, v3, 0x424c0000, v6
    v_cos_f32 v9, v7
    v_cos_f32 v10, v8
    v_sin_f32 v7, v7
    v_sin_f32 v8, v8
    v_mul_f32 v9, s50, v9
    v_mul_f32 v10, s50, v10
    v_mul_f32 v7, s50, v7
    v_mul_f32 v8, s50, v8
    v_cvt_pk_bf16_f32 v9, v9, v10
    v_cvt_pk_bf16_f32 v10, v7, v8
    v_cvt_pk_bf16_f32 v7, -v7, -v8
    v_accvgpr_write_b32 a63, v9
    v_accvgpr_write_b32 a79, v10
    v_accvgpr_write_b32 a95, v7
    s_add_u32 s62, s4, 14400
    s_add_u32 m0, s64, 9216
    s_nop 0
    buffer_load_dwordx4 v2, s[28:31], s62 offen  lds
    s_lshr_b32 s60, s48, 1
    s_lshl_b32 s60, s60, 5
    v_add_u32 v3, s60, v25
    v_lshlrev_b32 v4, 2, v26
    v_cvt_f32_u32 v4, v4
    v_add_u32 v5, 0, v3
    v_cvt_f32_u32 v5, v5
    v_mul_f32 v5, 0x3c800000, v5
    v_mul_f32 v6, v5, v4
    v_fmamk_f32 v7, v5, 0x0, v6
    v_fmamk_f32 v8, v5, 0x3f800000, v6
    v_cos_f32 v9, v7
    v_cos_f32 v10, v8
    v_sin_f32 v7, v7
    v_sin_f32 v8, v8
    v_cvt_pk_bf16_f32 v9, v9, v10
    v_cvt_pk_bf16_f32 v10, v7, v8
    v_cvt_pk_bf16_f32 v7, -v7, -v8
    v_accvgpr_write_b32 a0, v9
    v_accvgpr_write_b32 a16, v10
    v_accvgpr_write_b32 a32, v7
    v_fmamk_f32 v7, v5, 0x40000000, v6
    v_fmamk_f32 v8, v5, 0x40400000, v6
    v_cos_f32 v9, v7
    v_cos_f32 v10, v8
    v_sin_f32 v7, v7
    v_sin_f32 v8, v8
    v_cvt_pk_bf16_f32 v9, v9, v10
    v_cvt_pk_bf16_f32 v10, v7, v8
    v_cvt_pk_bf16_f32 v7, -v7, -v8
    v_accvgpr_write_b32 a1, v9
    v_accvgpr_write_b32 a17, v10
    v_accvgpr_write_b32 a33, v7
    v_fmamk_f32 v7, v5, 0x41800000, v6
    v_fmamk_f32 v8, v5, 0x41880000, v6
    v_cos_f32 v9, v7
    v_cos_f32 v10, v8
    v_sin_f32 v7, v7
    v_sin_f32 v8, v8
    v_cvt_pk_bf16_f32 v9, v9, v10
    v_cvt_pk_bf16_f32 v10, v7, v8
    v_cvt_pk_bf16_f32 v7, -v7, -v8
    v_accvgpr_write_b32 a2, v9
    v_accvgpr_write_b32 a18, v10
    v_accvgpr_write_b32 a34, v7
    v_fmamk_f32 v7, v5, 0x41900000, v6
    s_add_u32 s62, s4, 28800
    s_add_u32 m0, s64, 10240
    s_nop 0
    buffer_load_dwordx4 v2, s[28:31], s62 offen  lds
    v_fmamk_f32 v8, v5, 0x41980000, v6
    v_cos_f32 v9, v7
    v_cos_f32 v10, v8
    v_sin_f32 v7, v7
    v_sin_f32 v8, v8
    v_cvt_pk_bf16_f32 v9, v9, v10
    v_cvt_pk_bf16_f32 v10, v7, v8
    v_cvt_pk_bf16_f32 v7, -v7, -v8
    v_accvgpr_write_b32 a3, v9
    v_accvgpr_write_b32 a19, v10
    v_accvgpr_write_b32 a35, v7
    v_fmamk_f32 v7, v5, 0x42000000, v6
    v_fmamk_f32 v8, v5, 0x42040000, v6
    v_cos_f32 v9, v7
    v_cos_f32 v10, v8
    v_sin_f32 v7, v7
    v_sin_f32 v8, v8
    v_cvt_pk_bf16_f32 v9, v9, v10
    v_cvt_pk_bf16_f32 v10, v7, v8
    v_cvt_pk_bf16_f32 v7, -v7, -v8
    v_accvgpr_write_b32 a4, v9
    v_accvgpr_write_b32 a20, v10
    v_accvgpr_write_b32 a36, v7
    v_fmamk_f32 v7, v5, 0x42080000, v6
    v_fmamk_f32 v8, v5, 0x420c0000, v6
    v_cos_f32 v9, v7
    v_cos_f32 v10, v8
    v_sin_f32 v7, v7
    v_sin_f32 v8, v8
    v_cvt_pk_bf16_f32 v9, v9, v10
    v_cvt_pk_bf16_f32 v10, v7, v8
    v_cvt_pk_bf16_f32 v7, -v7, -v8
    v_accvgpr_write_b32 a5, v9
    v_accvgpr_write_b32 a21, v10
    v_accvgpr_write_b32 a37, v7
    v_fmamk_f32 v7, v5, 0x42400000, v6
    v_fmamk_f32 v8, v5, 0x42440000, v6
    v_cos_f32 v9, v7
    v_cos_f32 v10, v8
    v_sin_f32 v7, v7
    v_sin_f32 v8, v8
    v_cvt_pk_bf16_f32 v9, v9, v10
    v_cvt_pk_bf16_f32 v10, v7, v8
    v_cvt_pk_bf16_f32 v7, -v7, -v8
    v_accvgpr_write_b32 a6, v9
    s_add_u32 s62, s4, 43200
    s_add_u32 m0, s64, 11264
    s_nop 0
    buffer_load_dwordx4 v2, s[28:31], s62 offen  lds
    v_accvgpr_write_b32 a22, v10
    v_accvgpr_write_b32 a38, v7
    v_fmamk_f32 v7, v5, 0x42480000, v6
    v_fmamk_f32 v8, v5, 0x424c0000, v6
    v_cos_f32 v9, v7
    v_cos_f32 v10, v8
    v_sin_f32 v7, v7
    v_sin_f32 v8, v8
    v_cvt_pk_bf16_f32 v9, v9, v10
    v_cvt_pk_bf16_f32 v10, v7, v8
    v_cvt_pk_bf16_f32 v7, -v7, -v8
    v_accvgpr_write_b32 a7, v9
    v_accvgpr_write_b32 a23, v10
    v_accvgpr_write_b32 a39, v7
    v_add_u32 v5, 16, v3
    v_cvt_f32_u32 v5, v5
    v_mul_f32 v5, 0x3c800000, v5
    v_mul_f32 v6, v5, v4
    v_fmamk_f32 v7, v5, 0x0, v6
    v_fmamk_f32 v8, v5, 0x3f800000, v6
    v_cos_f32 v9, v7
    v_cos_f32 v10, v8
    v_sin_f32 v7, v7
    v_sin_f32 v8, v8
    v_cvt_pk_bf16_f32 v9, v9, v10
    v_cvt_pk_bf16_f32 v10, v7, v8
    v_cvt_pk_bf16_f32 v7, -v7, -v8
    v_accvgpr_write_b32 a8, v9
    v_accvgpr_write_b32 a24, v10
    v_accvgpr_write_b32 a40, v7
    v_fmamk_f32 v7, v5, 0x40000000, v6
    v_fmamk_f32 v8, v5, 0x40400000, v6
    v_cos_f32 v9, v7
    v_cos_f32 v10, v8
    v_sin_f32 v7, v7
    v_sin_f32 v8, v8
    v_cvt_pk_bf16_f32 v9, v9, v10
    v_cvt_pk_bf16_f32 v10, v7, v8
    v_cvt_pk_bf16_f32 v7, -v7, -v8
    v_accvgpr_write_b32 a9, v9
    v_accvgpr_write_b32 a25, v10
    v_accvgpr_write_b32 a41, v7
    v_fmamk_f32 v7, v5, 0x41800000, v6
    v_fmamk_f32 v8, v5, 0x41880000, v6
    v_cos_f32 v9, v7
    s_add_u32 s62, s4, 230400
    s_add_u32 m0, s64, 12288
    s_nop 0
    buffer_load_dwordx4 v2, s[28:31], s62 offen  lds
    v_cos_f32 v10, v8
    v_sin_f32 v7, v7
    v_sin_f32 v8, v8
    v_cvt_pk_bf16_f32 v9, v9, v10
    v_cvt_pk_bf16_f32 v10, v7, v8
    v_cvt_pk_bf16_f32 v7, -v7, -v8
    v_accvgpr_write_b32 a10, v9
    v_accvgpr_write_b32 a26, v10
    v_accvgpr_write_b32 a42, v7
    v_fmamk_f32 v7, v5, 0x41900000, v6
    v_fmamk_f32 v8, v5, 0x41980000, v6
    v_cos_f32 v9, v7
    v_cos_f32 v10, v8
    v_sin_f32 v7, v7
    v_sin_f32 v8, v8
    v_cvt_pk_bf16_f32 v9, v9, v10
    v_cvt_pk_bf16_f32 v10, v7, v8
    v_cvt_pk_bf16_f32 v7, -v7, -v8
    v_accvgpr_write_b32 a11, v9
    v_accvgpr_write_b32 a27, v10
    v_accvgpr_write_b32 a43, v7
    v_fmamk_f32 v7, v5, 0x42000000, v6
    v_fmamk_f32 v8, v5, 0x42040000, v6
    v_cos_f32 v9, v7
    v_cos_f32 v10, v8
    v_sin_f32 v7, v7
    v_sin_f32 v8, v8
    v_cvt_pk_bf16_f32 v9, v9, v10
    v_cvt_pk_bf16_f32 v10, v7, v8
    v_cvt_pk_bf16_f32 v7, -v7, -v8
    v_accvgpr_write_b32 a12, v9
    v_accvgpr_write_b32 a28, v10
    v_accvgpr_write_b32 a44, v7
    v_fmamk_f32 v7, v5, 0x42080000, v6
    v_fmamk_f32 v8, v5, 0x420c0000, v6
    v_cos_f32 v9, v7
    v_cos_f32 v10, v8
    v_sin_f32 v7, v7
    v_sin_f32 v8, v8
    v_cvt_pk_bf16_f32 v9, v9, v10
    v_cvt_pk_bf16_f32 v10, v7, v8
    v_cvt_pk_bf16_f32 v7, -v7, -v8
    v_accvgpr_write_b32 a13, v9
    v_accvgpr_write_b32 a29, v10
    v_accvgpr_write_b32 a45, v7
    s_add_u32 s62, s4, 244800
    s_add_u32 m0, s64, 13312
    s_nop 0
    buffer_load_dwordx4 v2, s[28:31], s62 offen  lds
    v_fmamk_f32 v7, v5, 0x42400000, v6
    v_fmamk_f32 v8, v5, 0x42440000, v6
    v_cos_f32 v9, v7
    v_cos_f32 v10, v8
    v_sin_f32 v7, v7
    v_sin_f32 v8, v8
    v_cvt_pk_bf16_f32 v9, v9, v10
    v_cvt_pk_bf16_f32 v10, v7, v8
    v_cvt_pk_bf16_f32 v7, -v7, -v8
    v_accvgpr_write_b32 a14, v9
    v_accvgpr_write_b32 a30, v10
    v_accvgpr_write_b32 a46, v7
    v_fmamk_f32 v7, v5, 0x42480000, v6
    v_fmamk_f32 v8, v5, 0x424c0000, v6
    v_cos_f32 v9, v7
    v_cos_f32 v10, v8
    v_sin_f32 v7, v7
    v_sin_f32 v8, v8
    v_cvt_pk_bf16_f32 v9, v9, v10
    v_cvt_pk_bf16_f32 v10, v7, v8
    v_cvt_pk_bf16_f32 v7, -v7, -v8
    v_accvgpr_write_b32 a15, v9
    v_accvgpr_write_b32 a31, v10
    v_accvgpr_write_b32 a47, v7
    v_mov_b32 v144, 0
    v_mov_b32 v145, 0
    v_mov_b32 v146, 0
    v_mov_b32 v147, 0
    v_mov_b32 v148, 0
    v_mov_b32 v149, 0
    v_mov_b32 v150, 0
    v_mov_b32 v151, 0
    v_mov_b32 v152, 0
    v_mov_b32 v153, 0
    v_mov_b32 v154, 0
    v_mov_b32 v155, 0
    v_mov_b32 v156, 0
    v_mov_b32 v157, 0
    v_mov_b32 v158, 0
    v_mov_b32 v159, 0
    v_mov_b32 v160, 0
    v_mov_b32 v161, 0
    v_mov_b32 v162, 0
    v_mov_b32 v163, 0
    v_mov_b32 v164, 0
    s_add_u32 s62, s4, 259200
    s_add_u32 m0, s64, 14336
    s_nop 0
    buffer_load_dwordx4 v2, s[28:31], s62 offen  lds
    v_mov_b32 v165, 0
    v_mov_b32 v166, 0
    v_mov_b32 v167, 0
    v_mov_b32 v168, 0
    v_mov_b32 v169, 0
    v_mov_b32 v170, 0
    v_mov_b32 v171, 0
    v_mov_b32 v172, 0
    v_mov_b32 v173, 0
    v_mov_b32 v174, 0
    v_mov_b32 v175, 0
    v_mov_b32 v176, 0
    v_mov_b32 v177, 0
    v_mov_b32 v178, 0
    v_mov_b32 v179, 0
    v_mov_b32 v180, 0
    v_mov_b32 v181, 0
    v_mov_b32 v182, 0
    v_mov_b32 v183, 0
    v_mov_b32 v184, 0
    v_mov_b32 v185, 0
    v_mov_b32 v186, 0
    v_mov_b32 v187, 0
    v_mov_b32 v188, 0
    v_mov_b32 v189, 0
    v_mov_b32 v190, 0
    v_mov_b32 v191, 0
    v_mov_b32 v192, 0
    v_mov_b32 v193, 0
    v_mov_b32 v194, 0
    v_mov_b32 v195, 0
    v_mov_b32 v196, 0
    v_mov_b32 v197, 0
    v_mov_b32 v198, 0
    v_mov_b32 v199, 0
    v_mov_b32 v200, 0
    v_mov_b32 v201, 0
    v_mov_b32 v202, 0
    v_mov_b32 v203, 0
    v_mov_b32 v204, 0
    v_mov_b32 v205, 0
    v_mov_b32 v206, 0
    v_mov_b32 v207, 0
    v_mov_b32 v208, 0
    v_mov_b32 v209, 0
    s_add_u32 s62, s4, 273600
    s_add_u32 m0, s64, 15360
    s_nop 0
    buffer_load_dwordx4 v2, s[28:31], s62 offen  lds
    v_mov_b32 v210, 0
    v_mov_b32 v211, 0
    v_mov_b32 v212, 0
    v_mov_b32 v213, 0
    v_mov_b32 v214, 0
    v_mov_b32 v215, 0
    v_mov_b32 v216, 0
    v_mov_b32 v217, 0
    v_mov_b32 v218, 0
    v_mov_b32 v219, 0
    v_mov_b32 v220, 0
    v_mov_b32 v221, 0
    v_mov_b32 v222, 0
    v_mov_b32 v223, 0
    v_mov_b32 v224, 0
    v_mov_b32 v225, 0
    v_mov_b32 v226, 0
    v_mov_b32 v227, 0
    v_mov_b32 v228, 0
    v_mov_b32 v229, 0
    v_mov_b32 v230, 0
    v_mov_b32 v231, 0
    v_mov_b32 v232, 0
    v_mov_b32 v233, 0
    v_mov_b32 v234, 0
    v_mov_b32 v235, 0
    v_mov_b32 v236, 0
    v_mov_b32 v237, 0
    v_mov_b32 v238, 0
    v_mov_b32 v239, 0
    v_mov_b32 v240, 0
    v_mov_b32 v241, 0
    v_mov_b32 v242, 0
    v_mov_b32 v243, 0
    v_mov_b32 v244, 0
    v_mov_b32 v245, 0
    v_mov_b32 v246, 0
    v_mov_b32 v247, 0
    v_mov_b32 v248, 0
    v_mov_b32 v249, 0
    v_mov_b32 v250, 0
    v_mov_b32 v251, 0
    v_mov_b32 v252, 0
    v_mov_b32 v253, 0
    v_mov_b32 v254, 0
    v_mov_b32 v255, 0
    v_lshlrev_b32 v28, 2, v25
    buffer_load_dword v29, v28, s[44:47], 0 offen offset:128 sc1
    v_lshlrev_b32 v3, 1, v25
    v_add_u32 v3, s5, v3
    v_and_b32 v4, 15, v3
    v_lshl_add_u32 v4, v26, 8, v4
    v_add_u32 v4, s64, v4
    v_lshrrev_b32 v3, 4, v3
    v_lshlrev_b32 v5, 1, v26
    v_add_u32 v6, 0, v3
    v_xor_b32 v6, v5, v6
    v_lshl_add_u32 v16, v6, 4, v4
    v_add_u32 v6, 2, v3
    v_xor_b32 v6, v5, v6
    v_lshl_add_u32 v17, v6, 4, v4
    v_add_u32 v6, 4, v3
    v_xor_b32 v6, v5, v6
    v_lshl_add_u32 v18, v6, 4, v4
    v_add_u32 v6, 6, v3
    v_xor_b32 v6, v5, v6
    v_lshl_add_u32 v19, v6, 4, v4
    v_add_u32 v6, 8, v3
    v_xor_b32 v6, v5, v6
    v_lshl_add_u32 v20, v6, 4, v4
    v_add_u32 v6, 10, v3
    v_xor_b32 v6, v5, v6
    v_lshl_add_u32 v21, v6, 4, v4
    v_add_u32 v6, 12, v3
    v_xor_b32 v6, v5, v6
    v_lshl_add_u32 v22, v6, 4, v4
    s_waitcnt vmcnt(1)
    ds_read_u16_d16_hi v144, v16 offset:0
    ds_read_u16_d16_hi v145, v16 offset:1024
    ds_read_u16_d16_hi v146, v16 offset:2048
    ds_read_u16_d16_hi v147, v16 offset:3072
    ds_read_u16_d16_hi v148, v16 offset:4096
    ds_read_u16_d16_hi v149, v16 offset:5120
    ds_read_u16_d16_hi v150, v16 offset:6144
    ds_read_u16_d16_hi v151, v16 offset:7168
    ds_read_u16_d16_hi v152, v16 offset:8192
    ds_read_u16_d16_hi v153, v16 offset:9216
    ds_read_u16_d16_hi v154, v16 offset:10240
    ds_read_u16_d16_hi v155, v16 offset:11264
    ds_read_u16_d16_hi v156, v16 offset:12288
    ds_read_u16_d16_hi v157, v16 offset:13312
    ds_read_u16_d16_hi v158, v16 offset:14336
    ds_read_u16_d16_hi v159, v16 offset:15360
    ds_read_u16_d16_hi v160, v17 offset:0
    ds_read_u16_d16_hi v161, v17 offset:1024
    ds_read_u16_d16_hi v162, v17 offset:2048
    ds_read_u16_d16_hi v163, v17 offset:3072
    ds_read_u16_d16_hi v164, v17 offset:4096
    ds_read_u16_d16_hi v165, v17 offset:5120
    ds_read_u16_d16_hi v166, v17 offset:6144
    ds_read_u16_d16_hi v167, v17 offset:7168
    ds_read_u16_d16_hi v168, v17 offset:8192
    ds_read_u16_d16_hi v169, v17 offset:9216
    ds_read_u16_d16_hi v170, v17 offset:10240
    ds_read_u16_d16_hi v171, v17 offset:11264
    ds_read_u16_d16_hi v172, v17 offset:12288
    ds_read_u16_d16_hi v173, v17 offset:13312
    ds_read_u16_d16_hi v174, v17 offset:14336
    ds_read_u16_d16_hi v175, v17 offset:15360
    ds_read_u16_d16_hi v176, v18 offset:0
    ds_read_u16_d16_hi v177, v18 offset:1024
    ds_read_u16_d16_hi v178, v18 offset:2048
    ds_read_u16_d16_hi v179, v18 offset:3072
    ds_read_u16_d16_hi v180, v18 offset:4096
    ds_read_u16_d16_hi v181, v18 offset:5120
    ds_read_u16_d16_hi v182, v18 offset:6144
    ds_read_u16_d16_hi v183, v18 offset:7168
    ds_read_u16_d16_hi v184, v18 offset:8192
    ds_read_u16_d16_hi v185, v18 offset:9216
    ds_read_u16_d16_hi v186, v18 offset:10240
    ds_read_u16_d16_hi v187, v18 offset:11264
    ds_read_u16_d16_hi v188, v18 offset:12288
    ds_read_u16_d16_hi v189, v18 offset:13312
    ds_read_u16_d16_hi v190, v18 offset:14336
    ds_read_u16_d16_hi v191, v18 offset:15360
    ds_read_u16_d16_hi v192, v19 offset:0
    ds_read_u16_d16_hi v193, v19 offset:1024
    ds_read_u16_d16_hi v194, v19 offset:2048
    ds_read_u16_d16_hi v195, v19 offset:3072
    ds_read_u16_d16_hi v196, v19 offset:4096
    ds_read_u16_d16_hi v197, v19 offset:5120
    ds_read_u16_d16_hi v198, v19 offset:6144
    ds_read_u16_d16_hi v199, v19 offset:7168
    ds_read_u16_d16_hi v200, v19 offset:8192
    ds_read_u16_d16_hi v201, v19 offset:9216
    ds_read_u16_d16_hi v202, v19 offset:10240
    ds_read_u16_d16_hi v203, v19 offset:11264
    ds_read_u16_d16_hi v204, v19 offset:12288
    ds_read_u16_d16_hi v205, v19 offset:13312
    ds_read_u16_d16_hi v206, v19 offset:14336
    ds_read_u16_d16_hi v207, v19 offset:15360
    ds_read_u16_d16_hi v208, v20 offset:0
    ds_read_u16_d16_hi v209, v20 offset:1024
    ds_read_u16_d16_hi v210, v20 offset:2048
    ds_read_u16_d16_hi v211, v20 offset:3072
    ds_read_u16_d16_hi v212, v20 offset:4096
    ds_read_u16_d16_hi v213, v20 offset:5120
    ds_read_u16_d16_hi v214, v20 offset:6144
    ds_read_u16_d16_hi v215, v20 offset:7168
    ds_read_u16_d16_hi v216, v20 offset:8192
    ds_read_u16_d16_hi v217, v20 offset:9216
    ds_read_u16_d16_hi v218, v20 offset:10240
    ds_read_u16_d16_hi v219, v20 offset:11264
    ds_read_u16_d16_hi v220, v20 offset:12288
    ds_read_u16_d16_hi v221, v20 offset:13312
    ds_read_u16_d16_hi v222, v20 offset:14336
    ds_read_u16_d16_hi v223, v20 offset:15360
    ds_read_u16_d16_hi v224, v21 offset:0
    ds_read_u16_d16_hi v225, v21 offset:1024
    ds_read_u16_d16_hi v226, v21 offset:2048
    ds_read_u16_d16_hi v227, v21 offset:3072
    ds_read_u16_d16_hi v228, v21 offset:4096
    ds_read_u16_d16_hi v229, v21 offset:5120
    ds_read_u16_d16_hi v230, v21 offset:6144
    ds_read_u16_d16_hi v231, v21 offset:7168
    ds_read_u16_d16_hi v232, v21 offset:8192
    ds_read_u16_d16_hi v233, v21 offset:9216
    ds_read_u16_d16_hi v234, v21 offset:10240
    ds_read_u16_d16_hi v235, v21 offset:11264
    ds_read_u16_d16_hi v236, v21 offset:12288
    ds_read_u16_d16_hi v237, v21 offset:13312
    ds_read_u16_d16_hi v238, v21 offset:14336
    ds_read_u16_d16_hi v239, v21 offset:15360
    ds_read_u16_d16_hi v240, v22 offset:0
    ds_read_u16_d16_hi v241, v22 offset:1024
    ds_read_u16_d16_hi v242, v22 offset:2048
    ds_read_u16_d16_hi v243, v22 offset:3072
    ds_read_u16_d16_hi v244, v22 offset:4096
    ds_read_u16_d16_hi v245, v22 offset:5120
    ds_read_u16_d16_hi v246, v22 offset:6144
    ds_read_u16_d16_hi v247, v22 offset:7168
    ds_read_u16_d16_hi v248, v22 offset:8192
    ds_read_u16_d16_hi v249, v22 offset:9216
    ds_read_u16_d16_hi v250, v22 offset:10240
    ds_read_u16_d16_hi v251, v22 offset:11264
    ds_read_u16_d16_hi v252, v22 offset:12288
    ds_read_u16_d16_hi v253, v22 offset:13312
    ds_read_u16_d16_hi v254, v22 offset:14336
    ds_read_u16_d16_hi v255, v22 offset:15360
    v_lshrrev_b32 v23, 3, v0
    v_and_b32 v24, 7, v0
    v_bfe_u32 v27, v0, 4, 2
    v_xor_b32 v27, v24, v27
    v_lshlrev_b32 v2, 7, v23
    v_lshl_add_u32 v2, v27, 4, v2
    v_lshlrev_b32 v3, 4, v25
    v_min_u32 v27, 2, v26
    v_lshl_add_u32 v4, v27, 10, v3
    v_add_u32 v4, 4096, v4
    v_lshl_add_u32 v3, v26, 10, v3
    v_lshrrev_b32 v27, 2, v0
    v_lshlrev_b32 v5, 7, v27
    v_bfe_u32 v27, v0, 3, 2
    s_and_b32 s60, s48, 1
    v_xor_b32 v27, s60, v27
    v_lshl_add_u32 v5, v27, 4, v5
    v_bfe_u32 v27, v0, 1, 1
    v_lshl_add_u32 v5, v27, 6, v5
    v_and_b32 v27, 1, v0
    v_lshl_add_u32 v5, v27, 3, v5
    v_xor_b32 v6, 32, v5
    s_lshl_b32 s60, s60, 12
    s_lshr_b32 s61, s48, 1
    s_lshl_b32 s61, s61, 11
    s_add_u32 s60, s60, s61
    s_add_u32 s60, s60, 65536
    v_add_u32 v7, s60, v1
    v_add_u32 v12, 65536, v1
    s_bfe_u32 s60, s51, 0x20001
    v_xor_b32 v27, s60, v26
    v_lshlrev_b32 v27, 1, v27
    v_xor_b32 v27, v27, v24
    v_lshlrev_b32 v8, 7, v25
    v_lshl_add_u32 v8, v27, 4, v8
    s_lshl_b32 s60, s48, 12
    s_add_u32 s60, s60, 131072
    v_add_u32 v8, s60, v8
    v_xor_b32 v9, 16, v8
    v_xor_b32 v27, v23, v24
    v_lshlrev_b32 v10, 7, v23
    v_lshl_add_u32 v10, v27, 4, v10
    v_add_u32 v10, s60, v10
    v_mul_u32_u24 v11, 28672, v23
    v_lshl_add_u32 v11, v24, 4, v11
    v_add_u32 v13, 229376, v11
    s_mul_i32 s70, s52, 7168
    s_lshl_b32 s60, s48, 8
    s_add_u32 s70, s70, s60
    s_add_u32 s70, s70, 12713984
    s_mul_i32 s71, s52, 917504
    s_lshl_b32 s60, s51, 13
    s_add_u32 s71, s71, s60
    s_lshl_b32 s64, s48, 11
    s_add_u32 s71, s71, s64
    s_add_u32 s71, s71, 7340032
    s_mul_i32 s4, s48, 458752
    s_mul_i32 s60, s52, 14336
    s_add_u32 s4, s4, s60
    s_lshl_b32 s60, s51, 7
    s_add_u32 s4, s4, s60
    s_add_u32 s4, s4, 9175040
    s_lshl_b32 s5, s48, 9
    s_lshl_b32 s60, s2, 4
    s_add_u32 s5, s5, s60
    s_add_u32 s5, s5, 12728320
    s_waitcnt vmcnt(0)
    v_cmp_eq_u32 vcc, 0, v29
    s_nop 0
    s_cbranch_vccnz L_slow_az
L_ok_az:
    s_waitcnt lgkmcnt(0)
    buffer_load_dword v29, v3, s[36:39], s70 offen sc1
    buffer_load_dword v30, v4, s[36:39], s70 offen sc1
    s_waitcnt vmcnt(0)
    v_min_u32 v29, v29, v30
    v_cmp_eq_u32 vcc, 0, v29
    s_nop 0
    s_cbranch_vccnz L_slow_ay
L_ok_ay:
    s_add_u32 s62, s71, 0
    s_add_u32 m0, s64, 0
    s_nop 0
    buffer_load_dwordx4 v2, s[36:39], s62 offen sc1 lds
    buffer_load_dwordx4 v2, s[36:39], s62 offen offset:1024 sc1 lds
    s_add_u32 s62, s71, 131072
    s_add_u32 m0, s64, 8192
    s_nop 0
    buffer_load_dwordx4 v2, s[36:39], s62 offen sc1 lds
    buffer_load_dwordx4 v2, s[36:39], s62 offen offset:1024 sc1 lds
    s_add_u32 s62, s71, 262144
    s_add_u32 m0, s64, 16384
    s_nop 0
    buffer_load_dwordx4 v2, s[36:39], s62 offen sc1 lds
    buffer_load_dwordx4 v2, s[36:39], s62 offen offset:1024 sc1 lds
    s_add_u32 s62, s71, 393216
    s_add_u32 m0, s64, 24576
    s_nop 0
    buffer_load_dwordx4 v2, s[36:39], s62 offen sc1 lds
    buffer_load_dwordx4 v2, s[36:39], s62 offen offset:1024 sc1 lds
    s_add_u32 s62, s71, 524288
    s_add_u32 m0, s64, 32768
    s_nop 0
    buffer_load_dwordx4 v2, s[36:39], s62 offen sc1 lds
    buffer_load_dwordx4 v2, s[36:39], s62 offen offset:1024 sc1 lds
    s_add_u32 s62, s71, 655360
    s_add_u32 m0, s64, 40960
    s_nop 0
    buffer_load_dwordx4 v2, s[36:39], s62 offen sc1 lds
    buffer_load_dwordx4 v2, s[36:39], s62 offen offset:1024 sc1 lds
    s_add_u32 s62, s71, 786432
    s_add_u32 m0, s64, 49152
    s_nop 0
    buffer_load_dwordx4 v2, s[36:39], s62 offen sc1 lds
    buffer_load_dwordx4 v2, s[36:39], s62 offen offset:1024 sc1 lds
    s_waitcnt vmcnt(10)
    s_barrier
    ds_read_b64_tr_b16 a[96:97], v5 offset:0
    ds_read_b64_tr_b16 a[98:99], v5 offset:2048
    ds_read_b64_tr_b16 a[100:101], v5 offset:4096
    ds_read_b64_tr_b16 a[102:103], v5 offset:6144
    ds_read_b64_tr_b16 a[104:105], v6 offset:0
    ds_read_b64_tr_b16 a[106:107], v6 offset:2048
    ds_read_b64_tr_b16 a[108:109], v6 offset:4096
    ds_read_b64_tr_b16 a[110:111], v6 offset:6144
    s_waitcnt lgkmcnt(0)
    v_mfma_f32_16x16x32_bf16 v[16:19], a[0:3], a[96:99], 0
    ds_read_b64_tr_b16 a[112:113], v5 offset:8192
    v_mfma_f32_16x16x32_bf16 v[20:23], a[8:11], a[96:99], 0
    ds_read_b64_tr_b16 a[114:115], v5 offset:10240
    v_mfma_f32_16x16x32_bf16 v[24:27], a[0:3], a[104:107], 0
    ds_read_b64_tr_b16 a[116:117], v5 offset:12288
    v_mfma_f32_16x16x32_bf16 v[28:31], a[8:11], a[104:107], 0
    v_mfma_f32_16x16x32_bf16 v[16:19], a[16:19], a[104:107], v[16:19]
    ds_read_b64_tr_b16 a[118:119], v5 offset:14336
    v_mfma_f32_16x16x32_bf16 v[20:23], a[24:27], a[104:107], v[20:23]
    ds_read_b64_tr_b16 a[120:121], v6 offset:8192
    v_mfma_f32_16x16x32_bf16 v[24:27], a[32:35], a[96:99], v[24:27]
    ds_read_b64_tr_b16 a[122:123], v6 offset:10240
    v_mfma_f32_16x16x32_bf16 v[28:31], a[40:43], a[96:99], v[28:31]
    v_mfma_f32_16x16x32_bf16 v[16:19], a[4:7], a[100:103], v[16:19]
    ds_read_b64_tr_b16 a[124:125], v6 offset:12288
    v_mfma_f32_16x16x32_bf16 v[20:23], a[12:15], a[100:103], v[20:23]
    ds_read_b64_tr_b16 a[126:127], v6 offset:14336
    v_mfma_f32_16x16x32_bf16 v[24:27], a[4:7], a[108:111], v[24:27]
    v_mfma_f32_16x16x32_bf16 v[28:31], a[12:15], a[108:111], v[28:31]
    v_mfma_f32_16x16x32_bf16 v[16:19], a[20:23], a[108:111], v[16:19]
    v_mfma_f32_16x16x32_bf16 v[20:23], a[28:31], a[108:111], v[20:23]
    v_mfma_f32_16x16x32_bf16 v[24:27], a[36:39], a[100:103], v[24:27]
    s_waitcnt vmcnt(6)
    s_barrier
    v_mfma_f32_16x16x32_bf16 v[28:31], a[44:47], a[100:103], v[28:31]
    s_waitcnt lgkmcnt(0)
    ds_read_b64_tr_b16 a[96:97], v5 offset:16384
    ds_read_b64_tr_b16 a[98:99], v5 offset:18432
    v_mfma_f32_16x16x32_bf16 v[32:35], a[0:3], a[112:115], 0
    ds_read_b64_tr_b16 a[100:101], v5 offset:20480
    ds_read_b64_tr_b16 a[102:103], v5 offset:22528
    v_mfma_f32_16x16x32_bf16 v[36:39], a[8:11], a[112:115], 0
    ds_read_b64_tr_b16 a[104:105], v6 offset:16384
    ds_read_b64_tr_b16 a[106:107], v6 offset:18432
    v_mul_f32 v14, v24, v152
    v_mul_f32 v152, v16, v152
    v_fma_f32 v16, v16, v144, -v14
    v_fma_f32 v24, v24, v144, v152
    v_mfma_f32_16x16x32_bf16 v[40:43], a[0:3], a[120:123], 0
    ds_read_b64_tr_b16 a[108:109], v6 offset:20480
    ds_read_b64_tr_b16 a[110:111], v6 offset:22528
    v_mul_f32 v15, v25, v153
    v_mul_f32 v153, v17, v153
    v_mfma_f32_16x16x32_bf16 v[44:47], a[8:11], a[120:123], 0
    v_fma_f32 v17, v17, v145, -v15
    v_fma_f32 v25, v25, v145, v153
    v_mul_f32 v14, v26, v154
    v_mfma_f32_16x16x32_bf16 v[32:35], a[16:19], a[120:123], v[32:35]
    v_mul_f32 v154, v18, v154
    v_fma_f32 v18, v18, v146, -v14
    v_fma_f32 v26, v26, v146, v154
    v_mfma_f32_16x16x32_bf16 v[36:39], a[24:27], a[120:123], v[36:39]
    v_mul_f32 v15, v27, v155
    v_mul_f32 v155, v19, v155
    v_fma_f32 v19, v19, v147, -v15
    v_mfma_f32_16x16x32_bf16 v[40:43], a[32:35], a[112:115], v[40:43]
    v_fma_f32 v27, v27, v147, v155
    v_mul_f32 v14, v28, v156
    v_mul_f32 v156, v20, v156
    v_mfma_f32_16x16x32_bf16 v[44:47], a[40:43], a[112:115], v[44:47]
    v_fma_f32 v20, v20, v148, -v14
    v_fma_f32 v28, v28, v148, v156
    v_mul_f32 v15, v29, v157
    v_mfma_f32_16x16x32_bf16 v[32:35], a[4:7], a[116:119], v[32:35]
    v_mul_f32 v157, v21, v157
    v_fma_f32 v21, v21, v149, -v15
    v_fma_f32 v29, v29, v149, v157
    v_mfma_f32_16x16x32_bf16 v[36:39], a[12:15], a[116:119], v[36:39]
    v_mul_f32 v14, v30, v158
    v_mul_f32 v158, v22, v158
    v_fma_f32 v22, v22, v150, -v14
    v_fma_f32 v30, v30, v150, v158
    v_mfma_f32_16x16x32_bf16 v[40:43], a[4:7], a[124:127], v[40:43]
    v_mul_f32 v15, v31, v159
    v_mul_f32 v159, v23, v159
    v_fma_f32 v23, v23, v151, -v15
    v_mfma_f32_16x16x32_bf16 v[44:47], a[12:15], a[124:127], v[44:47]
    v_fma_f32 v31, v31, v151, v159
    v_cvt_pk_bf16_f32 v144, v16, v17
    v_cvt_pk_bf16_f32 v145, v18, v19
    v_mfma_f32_16x16x32_bf16 v[32:35], a[20:23], a[124:127], v[32:35]
    v_cvt_pk_bf16_f32 v146, v20, v21
    v_cvt_pk_bf16_f32 v147, v22, v23
    v_cvt_pk_bf16_f32 v148, v24, v25
    v_mfma_f32_16x16x32_bf16 v[36:39], a[28:31], a[124:127], v[36:39]
    v_cvt_pk_bf16_f32 v149, v26, v27
    v_cvt_pk_bf16_f32 v150, v28, v29
    v_cvt_pk_bf16_f32 v151, v30, v31
    v_mfma_f32_16x16x32_bf16 v[40:43], a[36:39], a[116:119], v[40:43]
    ds_write_b128 v7, v[144:147] offset:0
    v_mfma_f32_16x16x32_bf16 v[44:47], a[44:47], a[116:119], v[44:47]
    s_waitcnt lgkmcnt(1)
    ds_write_b128 v7, v[148:151] offset:1024
    v_mfma_f32_16x16x32_bf16 v[16:19], a[0:3], a[96:99], 0
    ds_read_b64_tr_b16 a[112:113], v5 offset:24576
    ds_read_b64_tr_b16 a[114:115], v5 offset:26624
    v_mfma_f32_16x16x32_bf16 v[20:23], a[8:11], a[96:99], 0
    ds_read_b64_tr_b16 a[116:117], v5 offset:28672
    ds_read_b64_tr_b16 a[118:119], v5 offset:30720
    v_mul_f32 v14, v40, v168
    v_mul_f32 v168, v32, v168
    v_fma_f32 v32, v32, v160, -v14
    v_fma_f32 v40, v40, v160, v168
    v_mfma_f32_16x16x32_bf16 v[24:27], a[0:3], a[104:107], 0
    ds_read_b64_tr_b16 a[120:121], v6 offset:24576
    ds_read_b64_tr_b16 a[122:123], v6 offset:26624
    v_mul_f32 v15, v41, v169
    v_mul_f32 v169, v33, v169
    v_mfma_f32_16x16x32_bf16 v[28:31], a[8:11], a[104:107], 0
    ds_read_b64_tr_b16 a[124:125], v6 offset:28672
    ds_read_b64_tr_b16 a[126:127], v6 offset:30720
    v_fma_f32 v33, v33, v161, -v15
    v_fma_f32 v41, v41, v161, v169
    v_mfma_f32_16x16x32_bf16 v[16:19], a[16:19], a[104:107], v[16:19]
    v_mul_f32 v14, v42, v170
    v_mul_f32 v170, v34, v170
    v_fma_f32 v34, v34, v162, -v14
    v_mfma_f32_16x16x32_bf16 v[20:23], a[24:27], a[104:107], v[20:23]
    v_fma_f32 v42, v42, v162, v170
    v_mul_f32 v15, v43, v171
    v_mul_f32 v171, v35, v171
    v_mfma_f32_16x16x32_bf16 v[24:27], a[32:35], a[96:99], v[24:27]
    v_fma_f32 v35, v35, v163, -v15
    v_fma_f32 v43, v43, v163, v171
    v_mul_f32 v14, v44, v172
    v_mfma_f32_16x16x32_bf16 v[28:31], a[40:43], a[96:99], v[28:31]
    v_mul_f32 v172, v36, v172
    v_fma_f32 v36, v36, v164, -v14
    v_fma_f32 v44, v44, v164, v172
    v_mfma_f32_16x16x32_bf16 v[16:19], a[4:7], a[100:103], v[16:19]
    v_mul_f32 v15, v45, v173
    v_mul_f32 v173, v37, v173
    v_fma_f32 v37, v37, v165, -v15
    v_mfma_f32_16x16x32_bf16 v[20:23], a[12:15], a[100:103], v[20:23]
    v_fma_f32 v45, v45, v165, v173
    v_mul_f32 v14, v46, v174
    v_mul_f32 v174, v38, v174
    v_fma_f32 v38, v38, v166, -v14
    v_mfma_f32_16x16x32_bf16 v[24:27], a[4:7], a[108:111], v[24:27]
    v_fma_f32 v46, v46, v166, v174
    v_mul_f32 v15, v47, v175
    v_mul_f32 v175, v39, v175
    v_mfma_f32_16x16x32_bf16 v[28:31], a[12:15], a[108:111], v[28:31]
    v_fma_f32 v39, v39, v167, -v15
    v_fma_f32 v47, v47, v167, v175
    v_cvt_pk_bf16_f32 v160, v32, v33
    v_mfma_f32_16x16x32_bf16 v[16:19], a[20:23], a[108:111], v[16:19]
    v_cvt_pk_bf16_f32 v161, v34, v35
    v_cvt_pk_bf16_f32 v162, v36, v37
    v_cvt_pk_bf16_f32 v163, v38, v39
    v_mfma_f32_16x16x32_bf16 v[20:23], a[28:31], a[108:111], v[20:23]
    v_cvt_pk_bf16_f32 v164, v40, v41
    v_cvt_pk_bf16_f32 v165, v42, v43
    v_cvt_pk_bf16_f32 v166, v44, v45
    v_mfma_f32_16x16x32_bf16 v[24:27], a[36:39], a[100:103], v[24:27]
    v_cvt_pk_bf16_f32 v167, v46, v47
    v_mfma_f32_16x16x32_bf16 v[28:31], a[44:47], a[100:103], v[28:31]
    s_waitcnt lgkmcnt(0)
    ds_write_b128 v7, v[160:163] offset:8192
    ds_write_b128 v7, v[164:167] offset:9216
    v_mfma_f32_16x16x32_bf16 v[32:35], a[0:3], a[112:115], 0
    v_mfma_f32_16x16x32_bf16 v[36:39], a[8:11], a[112:115], 0
    s_nop 0
    v_mul_f32 v14, v24, v184
    v_mul_f32 v184, v16, v184
    v_mfma_f32_16x16x32_bf16 v[40:43], a[0:3], a[120:123], 0
    v_fma_f32 v16, v16, v176, -v14
    v_fma_f32 v24, v24, v176, v184
    v_mul_f32 v15, v25, v185
    v_mul_f32 v185, v17, v185
    v_mfma_f32_16x16x32_bf16 v[44:47], a[8:11], a[120:123], 0
    s_waitcnt lgkmcnt(0)
    s_waitcnt vmcnt(0)
    s_barrier
    ds_read_b128 a[128:131], v12 offset:0
    ds_read_b128 a[132:135], v12 offset:1024
    v_fma_f32 v17, v17, v177, -v15
    v_fma_f32 v25, v25, v177, v185
    v_mfma_f32_16x16x32_bf16 v[32:35], a[16:19], a[120:123], v[32:35]
    ds_read_b128 a[136:139], v12 offset:2048
    ds_read_b128 a[140:143], v12 offset:3072
    v_mul_f32 v14, v26, v186
    v_mul_f32 v186, v18, v186
    v_mfma_f32_16x16x32_bf16 v[36:39], a[24:27], a[120:123], v[36:39]
    ds_read_b128 a[144:147], v12 offset:4096
    ds_read_b128 a[148:151], v12 offset:5120
    v_fma_f32 v18, v18, v178, -v14
    v_fma_f32 v26, v26, v178, v186
    v_mul_f32 v15, v27, v187
    v_mfma_f32_16x16x32_bf16 v[40:43], a[32:35], a[112:115], v[40:43]
    ds_read_b128 a[152:155], v12 offset:6144
    ds_read_b128 a[156:159], v12 offset:7168
    v_mul_f32 v187, v19, v187
    v_fma_f32 v19, v19, v179, -v15
    v_fma_f32 v27, v27, v179, v187
    v_mfma_f32_16x16x32_bf16 v[44:47], a[40:43], a[112:115], v[44:47]
    ds_read_b128 a[160:163], v12 offset:8192
    ds_read_b128 a[164:167], v12 offset:9216
    v_mul_f32 v14, v28, v188
    v_mul_f32 v188, v20, v188
    v_mfma_f32_16x16x32_bf16 v[32:35], a[4:7], a[116:119], v[32:35]
    ds_read_b128 a[168:171], v12 offset:10240
    ds_read_b128 a[172:175], v12 offset:11264
    v_fma_f32 v20, v20, v180, -v14
    v_fma_f32 v28, v28, v180, v188
    v_mul_f32 v15, v29, v189
    v_mfma_f32_16x16x32_bf16 v[36:39], a[12:15], a[116:119], v[36:39]
    ds_read_b128 a[176:179], v12 offset:12288
    ds_read_b128 a[180:183], v12 offset:13312
    v_mul_f32 v189, v21, v189
    v_fma_f32 v21, v21, v181, -v15
    v_fma_f32 v29, v29, v181, v189
    v_mfma_f32_16x16x32_bf16 v[40:43], a[4:7], a[124:127], v[40:43]
    ds_read_b128 a[184:187], v12 offset:14336
    ds_read_b128 a[188:191], v12 offset:15360
    v_mul_f32 v14, v30, v190
    v_mul_f32 v190, v22, v190
    v_mfma_f32_16x16x32_bf16 v[44:47], a[12:15], a[124:127], v[44:47]
    v_fma_f32 v22, v22, v182, -v14
    v_fma_f32 v30, v30, v182, v190
    v_mul_f32 v15, v31, v191
    v_mul_f32 v191, v23, v191
    v_mfma_f32_16x16x32_bf16 v[32:35], a[20:23], a[124:127], v[32:35]
    v_fma_f32 v23, v23, v183, -v15
    v_fma_f32 v31, v31, v183, v191
    v_cvt_pk_bf16_f32 v176, v16, v17
    v_cvt_pk_bf16_f32 v177, v18, v19
    v_mfma_f32_16x16x32_bf16 v[36:39], a[28:31], a[124:127], v[36:39]
    v_cvt_pk_bf16_f32 v178, v20, v21
    v_cvt_pk_bf16_f32 v179, v22, v23
    v_cvt_pk_bf16_f32 v180, v24, v25
    v_mfma_f32_16x16x32_bf16 v[40:43], a[36:39], a[116:119], v[40:43]
    v_cvt_pk_bf16_f32 v181, v26, v27
    v_cvt_pk_bf16_f32 v182, v28, v29
    v_cvt_pk_bf16_f32 v183, v30, v31
    v_mfma_f32_16x16x32_bf16 v[44:47], a[44:47], a[116:119], v[44:47]
    s_waitcnt lgkmcnt(8)
    ds_write_b128 v7, v[176:179] offset:16384
    ds_write_b128 v7, v[180:183] offset:17408
    v_mfma_f32_16x16x32_bf16 v[48:51], a[128:131], a[48:51], 0
    v_mfma_f32_16x16x32_bf16 v[52:55], a[128:131], a[64:67], 0
    v_mul_f32 v14, v40, v200
    v_mfma_f32_16x16x32_bf16 v[56:59], a[144:147], a[56:59], 0
    v_mul_f32 v200, v32, v200
    v_fma_f32 v32, v32, v192, -v14
    v_fma_f32 v40, v40, v192, v200
    v_mul_f32 v15, v41, v201
    v_mfma_f32_16x16x32_bf16 v[60:63], a[144:147], a[72:75], 0
    v_mul_f32 v201, v33, v201
    v_fma_f32 v33, v33, v193, -v15
    v_fma_f32 v41, v41, v193, v201
    v_mfma_f32_16x16x32_bf16 v[48:51], a[132:135], a[80:83], v[48:51]
    v_mul_f32 v14, v42, v202
    v_mul_f32 v202, v34, v202
    v_fma_f32 v34, v34, v194, -v14
    v_mfma_f32_16x16x32_bf16 v[52:55], a[132:135], a[48:51], v[52:55]
    v_fma_f32 v42, v42, v194, v202
    v_mul_f32 v15, v43, v203
    v_mul_f32 v203, v35, v203
    v_mfma_f32_16x16x32_bf16 v[56:59], a[148:151], a[88:91], v[56:59]
    v_fma_f32 v35, v35, v195, -v15
    v_fma_f32 v43, v43, v195, v203
    v_mul_f32 v14, v44, v204
    v_mfma_f32_16x16x32_bf16 v[60:63], a[148:151], a[56:59], v[60:63]
    v_mul_f32 v204, v36, v204
    v_fma_f32 v36, v36, v196, -v14
    v_fma_f32 v44, v44, v196, v204
    v_mfma_f32_16x16x32_bf16 v[48:51], a[136:139], a[52:55], v[48:51]
    v_mul_f32 v15, v45, v205
    v_mul_f32 v205, v37, v205
    v_fma_f32 v37, v37, v197, -v15
    v_mfma_f32_16x16x32_bf16 v[52:55], a[136:139], a[68:71], v[52:55]
    v_fma_f32 v45, v45, v197, v205
    v_mul_f32 v14, v46, v206
    v_mul_f32 v206, v38, v206
    v_mfma_f32_16x16x32_bf16 v[56:59], a[152:155], a[60:63], v[56:59]
    v_fma_f32 v38, v38, v198, -v14
    v_fma_f32 v46, v46, v198, v206
    v_mul_f32 v15, v47, v207
    v_mfma_f32_16x16x32_bf16 v[60:63], a[152:155], a[76:79], v[60:63]
    v_mul_f32 v207, v39, v207
    v_fma_f32 v39, v39, v199, -v15
    v_fma_f32 v47, v47, v199, v207
    v_mfma_f32_16x16x32_bf16 v[48:51], a[140:143], a[84:87], v[48:51]
    v_cvt_pk_bf16_f32 v192, v32, v33
    v_cvt_pk_bf16_f32 v193, v34, v35
    v_cvt_pk_bf16_f32 v194, v36, v37
    v_mfma_f32_16x16x32_bf16 v[52:55], a[140:143], a[52:55], v[52:55]
    v_cvt_pk_bf16_f32 v195, v38, v39
    v_cvt_pk_bf16_f32 v196, v40, v41
    v_cvt_pk_bf16_f32 v197, v42, v43
    v_mfma_f32_16x16x32_bf16 v[56:59], a[156:159], a[92:95], v[56:59]
    v_cvt_pk_bf16_f32 v198, v44, v45
    v_cvt_pk_bf16_f32 v199, v46, v47
    v_mfma_f32_16x16x32_bf16 v[60:63], a[156:159], a[60:63], v[60:63]
    s_waitcnt lgkmcnt(2)
    ds_write_b128 v7, v[192:195] offset:24576
    ds_write_b128 v7, v[196:199] offset:25600
    v_mfma_f32_16x16x32_bf16 v[64:67], a[160:163], a[48:51], 0
    v_mfma_f32_16x16x32_bf16 v[68:71], a[160:163], a[64:67], 0
    v_add_f32 v80, v48, v56
    v_mfma_f32_16x16x32_bf16 v[72:75], a[176:179], a[56:59], 0
    ds_read_b64_tr_b16 a[96:97], v5 offset:32768
    ds_read_b64_tr_b16 a[98:99], v5 offset:34816
    v_add_f32 v81, v49, v57
    v_add_f32 v82, v50, v58
    v_mfma_f32_16x16x32_bf16 v[76:79], a[176:179], a[72:75], 0
    ds_read_b64_tr_b16 a[100:101], v5 offset:36864
    ds_read_b64_tr_b16 a[102:103], v5 offset:38912
    ds_read_b64_tr_b16 a[104:105], v6 offset:32768
    ds_read_b64_tr_b16 a[106:107], v6 offset:34816
    ds_read_b64_tr_b16 a[108:109], v6 offset:36864
    ds_read_b64_tr_b16 a[110:111], v6 offset:38912
    s_waitcnt lgkmcnt(8)
    s_barrier
    v_mfma_f32_16x16x32_bf16 v[64:67], a[164:167], a[80:83], v[64:67]
    ds_read_b128 a[128:131], v12 offset:16384
    ds_read_b128 a[132:135], v12 offset:17408
    v_add_f32 v83, v51, v59
    v_add_f32 v84, v52, v60
    v_mfma_f32_16x16x32_bf16 v[68:71], a[164:167], a[48:51], v[68:71]
    ds_read_b128 a[136:139], v12 offset:18432
    ds_read_b128 a[140:143], v12 offset:19456
    v_add_f32 v85, v53, v61
    v_add_f32 v86, v54, v62
    v_mfma_f32_16x16x32_bf16 v[72:75], a[180:183], a[88:91], v[72:75]
    ds_read_b128 a[144:147], v12 offset:20480
    ds_read_b128 a[148:151], v12 offset:21504
    v_add_f32 v87, v55, v63
    v_sub_f32 v48, v48, v56
    v_mfma_f32_16x16x32_bf16 v[76:79], a[180:183], a[56:59], v[76:79]
    ds_read_b128 a[152:155], v12 offset:22528
    ds_read_b128 a[156:159], v12 offset:23552
    v_sub_f32 v49, v49, v57
    v_sub_f32 v50, v50, v58
    v_mfma_f32_16x16x32_bf16 v[64:67], a[168:171], a[52:55], v[64:67]
    v_sub_f32 v51, v51, v59
    v_sub_f32 v52, v52, v60
    v_sub_f32 v53, v53, v61
    v_mfma_f32_16x16x32_bf16 v[68:71], a[168:171], a[68:71], v[68:71]
    v_sub_f32 v54, v54, v62
    v_sub_f32 v55, v55, v63
    v_cvt_pk_bf16_f32 v88, v80, v81
    v_mfma_f32_16x16x32_bf16 v[72:75], a[184:187], a[60:63], v[72:75]
    v_cvt_pk_bf16_f32 v89, v82, v83
    v_cvt_pk_bf16_f32 v90, v84, v85
    v_cvt_pk_bf16_f32 v91, v86, v87
    v_mfma_f32_16x16x32_bf16 v[76:79], a[184:187], a[76:79], v[76:79]
    v_cvt_pk_bf16_f32 v80, v48, v49
    v_cvt_pk_bf16_f32 v81, v50, v51
    v_cvt_pk_bf16_f32 v82, v52, v53
    v_mfma_f32_16x16x32_bf16 v[64:67], a[172:175], a[84:87], v[64:67]
    v_cvt_pk_bf16_f32 v83, v54, v55
    v_cvt_pk_bf16_f32 v84, -v48, -v49
    v_cvt_pk_bf16_f32 v85, -v50, -v51
    v_mfma_f32_16x16x32_bf16 v[68:71], a[172:175], a[52:55], v[68:71]
    v_cndmask_b32 v92, v82, v80, s[66:67]
    v_cndmask_b32 v93, v83, v81, s[66:67]
    v_cndmask_b32 v94, v84, v82, s[66:67]
    v_mfma_f32_16x16x32_bf16 v[72:75], a[188:191], a[92:95], v[72:75]
    v_cndmask_b32 v95, v85, v83, s[66:67]
    v_mfma_f32_16x16x32_bf16 v[76:79], a[188:191], a[60:63], v[76:79]
    s_waitcnt lgkmcnt(0)
    ds_write_b128 v8, v[88:91] offset:0
    ds_write_b128 v9, v[92:95] offset:0
    v_mfma_f32_16x16x32_bf16 v[48:51], a[128:131], a[48:51], 0
    ds_read_b128 a[160:163], v12 offset:24576
    ds_read_b128 a[164:167], v12 offset:25600
    v_mfma_f32_16x16x32_bf16 v[52:55], a[128:131], a[64:67], 0
    ds_read_b128 a[168:171], v12 offset:26624
    ds_read_b128 a[172:175], v12 offset:27648
    v_add_f32 v104, v64, v72
    v_add_f32 v105, v65, v73
    v_mfma_f32_16x16x32_bf16 v[56:59], a[144:147], a[56:59], 0
    ds_read_b128 a[176:179], v12 offset:28672
    ds_read_b128 a[180:183], v12 offset:29696
    v_add_f32 v106, v66, v74
    v_mfma_f32_16x16x32_bf16 v[60:63], a[144:147], a[72:75], 0
    ds_read_b128 a[184:187], v12 offset:30720
    ds_read_b128 a[188:191], v12 offset:31744
    v_add_f32 v107, v67, v75
    v_add_f32 v108, v68, v76
    v_mfma_f32_16x16x32_bf16 v[48:51], a[132:135], a[80:83], v[48:51]
    s_waitcnt lgkmcnt(8)
    ds_read_b128 v[96:99], v10 offset:0
    ds_read_b128 v[100:103], v10 offset:1024
    v_add_f32 v109, v69, v77
    v_mfma_f32_16x16x32_bf16 v[52:55], a[132:135], a[48:51], v[52:55]
    v_add_f32 v110, v70, v78
    v_add_f32 v111, v71, v79
    v_sub_f32 v64, v64, v72
    v_mfma_f32_16x16x32_bf16 v[56:59], a[148:151], a[88:91], v[56:59]
    v_sub_f32 v65, v65, v73
    v_sub_f32 v66, v66, v74
    v_sub_f32 v67, v67, v75
    v_mfma_f32_16x16x32_bf16 v[60:63], a[148:151], a[56:59], v[60:63]
    v_sub_f32 v68, v68, v76
    v_sub_f32 v69, v69, v77
    v_mfma_f32_16x16x32_bf16 v[48:51], a[136:139], a[52:55], v[48:51]
    v_sub_f32 v70, v70, v78
    v_sub_f32 v71, v71, v79
    v_cvt_pk_bf16_f32 v112, v104, v105
    v_mfma_f32_16x16x32_bf16 v[52:55], a[136:139], a[68:71], v[52:55]
    v_cvt_pk_bf16_f32 v113, v106, v107
    v_cvt_pk_bf16_f32 v114, v108, v109
    v_cvt_pk_bf16_f32 v115, v110, v111
    v_mfma_f32_16x16x32_bf16 v[56:59], a[152:155], a[60:63], v[56:59]
    v_cvt_pk_bf16_f32 v104, v64, v65
    v_cvt_pk_bf16_f32 v105, v66, v67
    v_mfma_f32_16x16x32_bf16 v[60:63], a[152:155], a[76:79], v[60:63]
    v_cvt_pk_bf16_f32 v106, v68, v69
    v_cvt_pk_bf16_f32 v107, v70, v71
    v_cvt_pk_bf16_f32 v108, -v64, -v65
    v_mfma_f32_16x16x32_bf16 v[48:51], a[140:143], a[84:87], v[48:51]
    v_cvt_pk_bf16_f32 v109, -v66, -v67
    v_cndmask_b32 v116, v106, v104, s[66:67]
    v_cndmask_b32 v117, v107, v105, s[66:67]
    v_mfma_f32_16x16x32_bf16 v[52:55], a[140:143], a[52:55], v[52:55]
    s_add_u32 s62, s4, 0
    s_waitcnt lgkmcnt(1)
    buffer_store_dwordx4 v[96:99], v11, s[36:39], s62 offen sc1
    v_cndmask_b32 v118, v108, v106, s[66:67]
    v_cndmask_b32 v119, v109, v107, s[66:67]
    v_mfma_f32_16x16x32_bf16 v[56:59], a[156:159], a[92:95], v[56:59]
    ds_write_b128 v8, v[112:115] offset:2048
    v_mfma_f32_16x16x32_bf16 v[60:63], a[156:159], a[60:63], v[60:63]
    ds_write_b128 v9, v[116:119] offset:2048
    s_waitcnt lgkmcnt(2)
    buffer_store_dwordx4 v[100:103], v13, s[36:39], s62 offen sc1
    v_mfma_f32_16x16x32_bf16 v[16:19], a[0:3], a[96:99], 0
    v_mfma_f32_16x16x32_bf16 v[20:23], a[8:11], a[96:99], 0
    s_nop 0
    v_add_f32 v80, v48, v56
    v_mfma_f32_16x16x32_bf16 v[24:27], a[0:3], a[104:107], 0
    ds_read_b64_tr_b16 a[112:113], v5 offset:40960
    ds_read_b64_tr_b16 a[114:115], v5 offset:43008
    v_add_f32 v81, v49, v57
    v_add_f32 v82, v50, v58
    v_mfma_f32_16x16x32_bf16 v[28:31], a[8:11], a[104:107], 0
    ds_read_b64_tr_b16 a[116:117], v5 offset:45056
    ds_read_b64_tr_b16 a[118:119], v5 offset:47104
    v_add_f32 v83, v51, v59
    v_add_f32 v84, v52, v60
    v_mfma_f32_16x16x32_bf16 v[16:19], a[16:19], a[104:107], v[16:19]
    s_waitcnt lgkmcnt(4)
    ds_read_b128 v[120:123], v10 offset:2048
    ds_read_b128 v[124:127], v10 offset:3072
    v_add_f32 v85, v53, v61
    v_mfma_f32_16x16x32_bf16 v[20:23], a[24:27], a[104:107], v[20:23]
    ds_read_b64_tr_b16 a[120:121], v6 offset:40960
    ds_read_b64_tr_b16 a[122:123], v6 offset:43008
    v_add_f32 v86, v54, v62
    v_add_f32 v87, v55, v63
    v_mfma_f32_16x16x32_bf16 v[24:27], a[32:35], a[96:99], v[24:27]
    ds_read_b64_tr_b16 a[124:125], v6 offset:45056
    ds_read_b64_tr_b16 a[126:127], v6 offset:47104
    v_sub_f32 v48, v48, v56
    v_sub_f32 v49, v49, v57
    v_mfma_f32_16x16x32_bf16 v[28:31], a[40:43], a[96:99], v[28:31]
    v_sub_f32 v50, v50, v58
    v_sub_f32 v51, v51, v59
    v_sub_f32 v52, v52, v60
    v_mfma_f32_16x16x32_bf16 v[16:19], a[4:7], a[100:103], v[16:19]
    v_sub_f32 v53, v53, v61
    v_sub_f32 v54, v54, v62
    v_sub_f32 v55, v55, v63
    v_mfma_f32_16x16x32_bf16 v[20:23], a[12:15], a[100:103], v[20:23]
    v_cvt_pk_bf16_f32 v88, v80, v81
    v_cvt_pk_bf16_f32 v89, v82, v83
    v_cvt_pk_bf16_f32 v90, v84, v85
    v_mfma_f32_16x16x32_bf16 v[24:27], a[4:7], a[108:111], v[24:27]
    v_cvt_pk_bf16_f32 v91, v86, v87
    v_cvt_pk_bf16_f32 v80, v48, v49
    v_mfma_f32_16x16x32_bf16 v[28:31], a[12:15], a[108:111], v[28:31]
    v_cvt_pk_bf16_f32 v81, v50, v51
    v_cvt_pk_bf16_f32 v82, v52, v53
    v_cvt_pk_bf16_f32 v83, v54, v55
    v_mfma_f32_16x16x32_bf16 v[16:19], a[20:23], a[108:111], v[16:19]
    v_cvt_pk_bf16_f32 v84, -v48, -v49
    v_cvt_pk_bf16_f32 v85, -v50, -v51
    v_cndmask_b32 v92, v82, v80, s[66:67]
    v_mfma_f32_16x16x32_bf16 v[20:23], a[28:31], a[108:111], v[20:23]
    v_cndmask_b32 v93, v83, v81, s[66:67]
    v_cndmask_b32 v94, v84, v82, s[66:67]
    v_cndmask_b32 v95, v85, v83, s[66:67]
    v_mfma_f32_16x16x32_bf16 v[24:27], a[36:39], a[100:103], v[24:27]
    ds_write_b128 v8, v[88:91] offset:0
    v_mfma_f32_16x16x32_bf16 v[28:31], a[44:47], a[100:103], v[28:31]
    ds_write_b128 v9, v[92:95] offset:0
    s_add_u32 s62, s4, 2048
    s_waitcnt lgkmcnt(7)
    buffer_store_dwordx4 v[120:123], v11, s[36:39], s62 offen sc1
    s_waitcnt lgkmcnt(6)
    buffer_store_dwordx4 v[124:127], v13, s[36:39], s62 offen sc1
    v_mfma_f32_16x16x32_bf16 v[64:67], a[160:163], a[48:51], 0
    v_mfma_f32_16x16x32_bf16 v[68:71], a[160:163], a[64:67], 0
    v_mul_f32 v14, v24, v216
    v_mul_f32 v216, v16, v216
    v_mfma_f32_16x16x32_bf16 v[72:75], a[176:179], a[56:59], 0
    ds_read_b64_tr_b16 a[96:97], v5 offset:49152
    ds_read_b64_tr_b16 a[98:99], v5 offset:51200
    v_fma_f32 v16, v16, v208, -v14
    v_fma_f32 v24, v24, v208, v216
    v_mfma_f32_16x16x32_bf16 v[76:79], a[176:179], a[72:75], 0
    ds_read_b64_tr_b16 a[100:101], v5 offset:53248
    ds_read_b64_tr_b16 a[102:103], v5 offset:55296
    v_mul_f32 v15, v25, v217
    v_mul_f32 v217, v17, v217
    v_fma_f32 v17, v17, v209, -v15
    v_mfma_f32_16x16x32_bf16 v[64:67], a[164:167], a[80:83], v[64:67]
    s_waitcnt lgkmcnt(4)
    ds_read_b128 v[96:99], v10 offset:0
    ds_read_b128 v[100:103], v10 offset:1024
    v_fma_f32 v25, v25, v209, v217
    v_mul_f32 v14, v26, v218
    v_mfma_f32_16x16x32_bf16 v[68:71], a[164:167], a[48:51], v[68:71]
    ds_read_b64_tr_b16 a[104:105], v6 offset:49152
    ds_read_b64_tr_b16 a[106:107], v6 offset:51200
    v_mul_f32 v218, v18, v218
    v_fma_f32 v18, v18, v210, -v14
    v_fma_f32 v26, v26, v210, v218
    v_mfma_f32_16x16x32_bf16 v[72:75], a[180:183], a[88:91], v[72:75]
    ds_read_b64_tr_b16 a[108:109], v6 offset:53248
    ds_read_b64_tr_b16 a[110:111], v6 offset:55296
    v_mul_f32 v15, v27, v219
    v_mul_f32 v219, v19, v219
    v_mfma_f32_16x16x32_bf16 v[76:79], a[180:183], a[56:59], v[76:79]
    v_fma_f32 v19, v19, v211, -v15
    v_fma_f32 v27, v27, v211, v219
    v_mul_f32 v14, v28, v220
    v_mul_f32 v220, v20, v220
    v_mfma_f32_16x16x32_bf16 v[64:67], a[168:171], a[52:55], v[64:67]
    v_fma_f32 v20, v20, v212, -v14
    v_fma_f32 v28, v28, v212, v220
    v_mul_f32 v15, v29, v221
    v_mfma_f32_16x16x32_bf16 v[68:71], a[168:171], a[68:71], v[68:71]
    v_mul_f32 v221, v21, v221
    v_fma_f32 v21, v21, v213, -v15
    v_fma_f32 v29, v29, v213, v221
    v_mul_f32 v14, v30, v222
    v_mfma_f32_16x16x32_bf16 v[72:75], a[184:187], a[60:63], v[72:75]
    v_mul_f32 v222, v22, v222
    v_fma_f32 v22, v22, v214, -v14
    v_fma_f32 v30, v30, v214, v222
    v_mfma_f32_16x16x32_bf16 v[76:79], a[184:187], a[76:79], v[76:79]
    v_mul_f32 v15, v31, v223
    v_mul_f32 v223, v23, v223
    v_fma_f32 v23, v23, v215, -v15
    v_fma_f32 v31, v31, v215, v223
    v_mfma_f32_16x16x32_bf16 v[64:67], a[172:175], a[84:87], v[64:67]
    v_cvt_pk_bf16_f32 v208, v16, v17
    v_cvt_pk_bf16_f32 v209, v18, v19
    v_cvt_pk_bf16_f32 v210, v20, v21
    v_mfma_f32_16x16x32_bf16 v[68:71], a[172:175], a[52:55], v[68:71]
    v_cvt_pk_bf16_f32 v211, v22, v23
    v_cvt_pk_bf16_f32 v212, v24, v25
    v_cvt_pk_bf16_f32 v213, v26, v27
    v_cvt_pk_bf16_f32 v214, v28, v29
    v_mfma_f32_16x16x32_bf16 v[72:75], a[188:191], a[92:95], v[72:75]
    s_add_u32 s62, s4, 4096
    s_waitcnt lgkmcnt(5)
    buffer_store_dwordx4 v[96:99], v11, s[36:39], s62 offen sc1
    s_waitcnt lgkmcnt(4)
    buffer_store_dwordx4 v[100:103], v13, s[36:39], s62 offen sc1
    v_cvt_pk_bf16_f32 v215, v30, v31
    v_mfma_f32_16x16x32_bf16 v[76:79], a[188:191], a[60:63], v[76:79]
    ds_write_b128 v7, v[208:211] offset:32768
    ds_write_b128 v7, v[212:215] offset:33792
    v_mfma_f32_16x16x32_bf16 v[32:35], a[0:3], a[112:115], 0
    v_mfma_f32_16x16x32_bf16 v[36:39], a[8:11], a[112:115], 0
    v_add_f32 v104, v64, v72
    v_mfma_f32_16x16x32_bf16 v[40:43], a[0:3], a[120:123], 0
    v_add_f32 v105, v65, v73
    v_add_f32 v106, v66, v74
    v_mfma_f32_16x16x32_bf16 v[44:47], a[8:11], a[120:123], 0
    v_add_f32 v107, v67, v75
    v_add_f32 v108, v68, v76
    v_mfma_f32_16x16x32_bf16 v[32:35], a[16:19], a[120:123], v[32:35]
    v_add_f32 v109, v69, v77
    v_add_f32 v110, v70, v78
    v_add_f32 v111, v71, v79
    v_mfma_f32_16x16x32_bf16 v[36:39], a[24:27], a[120:123], v[36:39]
    v_sub_f32 v64, v64, v72
    v_sub_f32 v65, v65, v73
    v_mfma_f32_16x16x32_bf16 v[40:43], a[32:35], a[112:115], v[40:43]
    v_sub_f32 v66, v66, v74
    v_sub_f32 v67, v67, v75
    v_sub_f32 v68, v68, v76
    v_mfma_f32_16x16x32_bf16 v[44:47], a[40:43], a[112:115], v[44:47]
    v_sub_f32 v69, v69, v77
    v_sub_f32 v70, v70, v78
    v_mfma_f32_16x16x32_bf16 v[32:35], a[4:7], a[116:119], v[32:35]
    v_sub_f32 v71, v71, v79
    v_cvt_pk_bf16_f32 v112, v104, v105
    v_cvt_pk_bf16_f32 v113, v106, v107
    v_mfma_f32_16x16x32_bf16 v[36:39], a[12:15], a[116:119], v[36:39]
    v_cvt_pk_bf16_f32 v114, v108, v109
    v_cvt_pk_bf16_f32 v115, v110, v111
    v_mfma_f32_16x16x32_bf16 v[40:43], a[4:7], a[124:127], v[40:43]
    v_cvt_pk_bf16_f32 v104, v64, v65
    v_cvt_pk_bf16_f32 v105, v66, v67
    v_mfma_f32_16x16x32_bf16 v[44:47], a[12:15], a[124:127], v[44:47]
    v_cvt_pk_bf16_f32 v106, v68, v69
    v_cvt_pk_bf16_f32 v107, v70, v71
    v_cvt_pk_bf16_f32 v108, -v64, -v65
    v_mfma_f32_16x16x32_bf16 v[32:35], a[20:23], a[124:127], v[32:35]
    v_cvt_pk_bf16_f32 v109, -v66, -v67
    v_cndmask_b32 v116, v106, v104, s[66:67]
    v_mfma_f32_16x16x32_bf16 v[36:39], a[28:31], a[124:127], v[36:39]
    v_cndmask_b32 v117, v107, v105, s[66:67]
    v_cndmask_b32 v118, v108, v106, s[66:67]
    v_cndmask_b32 v119, v109, v107, s[66:67]
    v_mfma_f32_16x16x32_bf16 v[40:43], a[36:39], a[116:119], v[40:43]
    ds_write_b128 v8, v[112:115] offset:2048
    v_mfma_f32_16x16x32_bf16 v[44:47], a[44:47], a[116:119], v[44:47]
    s_waitcnt lgkmcnt(3)
    ds_write_b128 v9, v[116:119] offset:2048
    v_mfma_f32_16x16x32_bf16 v[16:19], a[0:3], a[96:99], 0
    v_mfma_f32_16x16x32_bf16 v[20:23], a[8:11], a[96:99], 0
    s_nop 1
    v_mul_f32 v14, v40, v232
    v_mul_f32 v232, v32, v232
    v_mfma_f32_16x16x32_bf16 v[24:27], a[0:3], a[104:107], 0
    v_fma_f32 v32, v32, v224, -v14
    v_fma_f32 v40, v40, v224, v232
    v_mul_f32 v15, v41, v233
    v_mfma_f32_16x16x32_bf16 v[28:31], a[8:11], a[104:107], 0
    s_waitcnt lgkmcnt(2)
    s_barrier
    ds_read_b128 a[128:131], v12 offset:32768
    ds_read_b128 a[132:135], v12 offset:33792
    v_mul_f32 v233, v33, v233
    v_fma_f32 v33, v33, v225, -v15
    v_mfma_f32_16x16x32_bf16 v[16:19], a[16:19], a[104:107], v[16:19]
    s_waitcnt lgkmcnt(2)
    ds_read_b128 v[120:123], v10 offset:2048
    ds_read_b128 v[124:127], v10 offset:3072
    v_fma_f32 v41, v41, v225, v233
    v_mul_f32 v14, v42, v234
    v_mul_f32 v234, v34, v234
    v_mfma_f32_16x16x32_bf16 v[20:23], a[24:27], a[104:107], v[20:23]
    ds_read_b128 a[136:139], v12 offset:34816
    ds_read_b128 a[140:143], v12 offset:35840
    v_fma_f32 v34, v34, v226, -v14
    v_fma_f32 v42, v42, v226, v234
    v_mfma_f32_16x16x32_bf16 v[24:27], a[32:35], a[96:99], v[24:27]
    ds_read_b128 a[144:147], v12 offset:36864
    ds_read_b128 a[148:151], v12 offset:37888
    v_mul_f32 v15, v43, v235
    v_mul_f32 v235, v35, v235
    v_fma_f32 v35, v35, v227, -v15
    v_mfma_f32_16x16x32_bf16 v[28:31], a[40:43], a[96:99], v[28:31]
    ds_read_b128 a[152:155], v12 offset:38912
    ds_read_b128 a[156:159], v12 offset:39936
    v_fma_f32 v43, v43, v227, v235
    v_mul_f32 v14, v44, v236
    v_mfma_f32_16x16x32_bf16 v[16:19], a[4:7], a[100:103], v[16:19]
    v_mul_f32 v236, v36, v236
    v_fma_f32 v36, v36, v228, -v14
    v_fma_f32 v44, v44, v228, v236
    v_mul_f32 v15, v45, v237
    v_mfma_f32_16x16x32_bf16 v[20:23], a[12:15], a[100:103], v[20:23]
    v_mul_f32 v237, v37, v237
    v_fma_f32 v37, v37, v229, -v15
    v_fma_f32 v45, v45, v229, v237
    v_mfma_f32_16x16x32_bf16 v[24:27], a[4:7], a[108:111], v[24:27]
    v_mul_f32 v14, v46, v238
    v_mul_f32 v238, v38, v238
    v_fma_f32 v38, v38, v230, -v14
    v_fma_f32 v46, v46, v230, v238
    v_mfma_f32_16x16x32_bf16 v[28:31], a[12:15], a[108:111], v[28:31]
    v_mul_f32 v15, v47, v239
    v_mul_f32 v239, v39, v239
    v_fma_f32 v39, v39, v231, -v15
    v_fma_f32 v47, v47, v231, v239
    v_mfma_f32_16x16x32_bf16 v[16:19], a[20:23], a[108:111], v[16:19]
    v_cvt_pk_bf16_f32 v224, v32, v33
    v_cvt_pk_bf16_f32 v225, v34, v35
    v_cvt_pk_bf16_f32 v226, v36, v37
    v_mfma_f32_16x16x32_bf16 v[20:23], a[28:31], a[108:111], v[20:23]
    v_cvt_pk_bf16_f32 v227, v38, v39
    v_cvt_pk_bf16_f32 v228, v40, v41
    v_cvt_pk_bf16_f32 v229, v42, v43
    v_cvt_pk_bf16_f32 v230, v44, v45
    v_mfma_f32_16x16x32_bf16 v[24:27], a[36:39], a[100:103], v[24:27]
    s_add_u32 s62, s4, 6144
    s_waitcnt lgkmcnt(7)
    buffer_store_dwordx4 v[120:123], v11, s[36:39], s62 offen sc1
    s_waitcnt lgkmcnt(6)
    buffer_store_dwordx4 v[124:127], v13, s[36:39], s62 offen sc1
    v_cvt_pk_bf16_f32 v231, v46, v47
    v_mfma_f32_16x16x32_bf16 v[28:31], a[44:47], a[100:103], v[28:31]
    s_waitcnt lgkmcnt(0)
    ds_write_b128 v7, v[224:227] offset:40960
    ds_write_b128 v7, v[228:231] offset:41984
    v_mfma_f32_16x16x32_bf16 v[48:51], a[128:131], a[48:51], 0
    v_mfma_f32_16x16x32_bf16 v[52:55], a[128:131], a[64:67], 0
    v_mul_f32 v14, v24, v248
    v_mul_f32 v248, v16, v248
    v_mfma_f32_16x16x32_bf16 v[56:59], a[144:147], a[56:59], 0
    v_fma_f32 v16, v16, v240, -v14
    v_fma_f32 v24, v24, v240, v248
    v_mul_f32 v15, v25, v249
    v_mfma_f32_16x16x32_bf16 v[60:63], a[144:147], a[72:75], 0
    s_waitcnt lgkmcnt(0)
    s_barrier
    ds_read_b128 a[160:163], v12 offset:40960
    ds_read_b128 a[164:167], v12 offset:41984
    v_mul_f32 v249, v17, v249
    v_fma_f32 v17, v17, v241, -v15
    v_mfma_f32_16x16x32_bf16 v[48:51], a[132:135], a[80:83], v[48:51]
    ds_read_b128 a[168:171], v12 offset:43008
    ds_read_b128 a[172:175], v12 offset:44032
    v_fma_f32 v25, v25, v241, v249
    v_mul_f32 v14, v26, v250
    v_mfma_f32_16x16x32_bf16 v[52:55], a[132:135], a[48:51], v[52:55]
    ds_read_b128 a[176:179], v12 offset:45056
    ds_read_b128 a[180:183], v12 offset:46080
    v_mul_f32 v250, v18, v250
    v_fma_f32 v18, v18, v242, -v14
    v_fma_f32 v26, v26, v242, v250
    v_mfma_f32_16x16x32_bf16 v[56:59], a[148:151], a[88:91], v[56:59]
    ds_read_b128 a[184:187], v12 offset:47104
    ds_read_b128 a[188:191], v12 offset:48128
    v_mul_f32 v15, v27, v251
    v_mul_f32 v251, v19, v251
    v_mfma_f32_16x16x32_bf16 v[60:63], a[148:151], a[56:59], v[60:63]
    v_fma_f32 v19, v19, v243, -v15
    v_fma_f32 v27, v27, v243, v251
    v_mul_f32 v14, v28, v252
    v_mfma_f32_16x16x32_bf16 v[48:51], a[136:139], a[52:55], v[48:51]
    v_mul_f32 v252, v20, v252
    v_fma_f32 v20, v20, v244, -v14
    v_fma_f32 v28, v28, v244, v252
    v_mul_f32 v15, v29, v253
    v_mfma_f32_16x16x32_bf16 v[52:55], a[136:139], a[68:71], v[52:55]
    v_mul_f32 v253, v21, v253
    v_fma_f32 v21, v21, v245, -v15
    v_fma_f32 v29, v29, v245, v253
    v_mfma_f32_16x16x32_bf16 v[56:59], a[152:155], a[60:63], v[56:59]
    v_mul_f32 v14, v30, v254
    v_mul_f32 v254, v22, v254
    v_fma_f32 v22, v22, v246, -v14
    v_fma_f32 v30, v30, v246, v254
    v_mfma_f32_16x16x32_bf16 v[60:63], a[152:155], a[76:79], v[60:63]
    v_mul_f32 v15, v31, v255
    v_mul_f32 v255, v23, v255
    v_fma_f32 v23, v23, v247, -v15
    v_mfma_f32_16x16x32_bf16 v[48:51], a[140:143], a[84:87], v[48:51]
    v_fma_f32 v31, v31, v247, v255
    v_cvt_pk_bf16_f32 v240, v16, v17
    v_cvt_pk_bf16_f32 v241, v18, v19
    v_mfma_f32_16x16x32_bf16 v[52:55], a[140:143], a[52:55], v[52:55]
    v_cvt_pk_bf16_f32 v242, v20, v21
    v_cvt_pk_bf16_f32 v243, v22, v23
    v_cvt_pk_bf16_f32 v244, v24, v25
    v_cvt_pk_bf16_f32 v245, v26, v27
    v_mfma_f32_16x16x32_bf16 v[56:59], a[156:159], a[92:95], v[56:59]
    v_cvt_pk_bf16_f32 v246, v28, v29
    v_cvt_pk_bf16_f32 v247, v30, v31
    v_mfma_f32_16x16x32_bf16 v[60:63], a[156:159], a[60:63], v[60:63]
    s_waitcnt lgkmcnt(0)
    ds_write_b128 v7, v[240:243] offset:49152
    ds_write_b128 v7, v[244:247] offset:50176
    v_mfma_f32_16x16x32_bf16 v[64:67], a[160:163], a[48:51], 0
    v_mfma_f32_16x16x32_bf16 v[68:71], a[160:163], a[64:67], 0
    v_add_f32 v80, v48, v56
    v_mfma_f32_16x16x32_bf16 v[72:75], a[176:179], a[56:59], 0
    v_add_f32 v81, v49, v57
    v_add_f32 v82, v50, v58
    v_add_f32 v83, v51, v59
    v_mfma_f32_16x16x32_bf16 v[76:79], a[176:179], a[72:75], 0
    s_waitcnt lgkmcnt(0)
    s_barrier
    v_mov_b32 v2, 0
    v_mov_b32 v3, 1
    s_waitcnt vmcnt(0)
    s_mov_b64 exec, 1
    buffer_store_dword v3, v2, s[36:39], s5 offen sc1
    s_mov_b64 exec, -1
    s_add_u32 s5, s5, 16384
    v_mfma_f32_16x16x32_bf16 v[64:67], a[164:167], a[80:83], v[64:67]
    ds_read_b128 a[128:131], v12 offset:49152
    ds_read_b128 a[132:135], v12 offset:50176
    v_add_f32 v84, v52, v60
    v_add_f32 v85, v53, v61
    v_mfma_f32_16x16x32_bf16 v[68:71], a[164:167], a[48:51], v[68:71]
    ds_read_b128 a[136:139], v12 offset:51200
    ds_read_b128 a[140:143], v12 offset:52224
    v_add_f32 v86, v54, v62
    v_add_f32 v87, v55, v63
    v_mfma_f32_16x16x32_bf16 v[72:75], a[180:183], a[88:91], v[72:75]
    ds_read_b128 a[144:147], v12 offset:53248
    ds_read_b128 a[148:151], v12 offset:54272
    v_sub_f32 v48, v48, v56
    v_sub_f32 v49, v49, v57
    v_mfma_f32_16x16x32_bf16 v[76:79], a[180:183], a[56:59], v[76:79]
    ds_read_b128 a[152:155], v12 offset:55296
    ds_read_b128 a[156:159], v12 offset:56320
    v_sub_f32 v50, v50, v58
    v_mfma_f32_16x16x32_bf16 v[64:67], a[168:171], a[52:55], v[64:67]
    v_sub_f32 v51, v51, v59
    v_sub_f32 v52, v52, v60
    v_sub_f32 v53, v53, v61
    v_mfma_f32_16x16x32_bf16 v[68:71], a[168:171], a[68:71], v[68:71]
    v_sub_f32 v54, v54, v62
    v_sub_f32 v55, v55, v63
    v_cvt_pk_bf16_f32 v88, v80, v81
    v_mfma_f32_16x16x32_bf16 v[72:75], a[184:187], a[60:63], v[72:75]
    v_cvt_pk_bf16_f32 v89, v82, v83
    v_cvt_pk_bf16_f32 v90, v84, v85
    v_cvt_pk_bf16_f32 v91, v86, v87
    v_mfma_f32_16x16x32_bf16 v[76:79], a[184:187], a[76:79], v[76:79]
    v_cvt_pk_bf16_f32 v80, v48, v49
    v_cvt_pk_bf16_f32 v81, v50, v51
    v_cvt_pk_bf16_f32 v82, v52, v53
    v_mfma_f32_16x16x32_bf16 v[64:67], a[172:175], a[84:87], v[64:67]
    v_cvt_pk_bf16_f32 v83, v54, v55
    v_cvt_pk_bf16_f32 v84, -v48, -v49
    v_cvt_pk_bf16_f32 v85, -v50, -v51
    v_mfma_f32_16x16x32_bf16 v[68:71], a[172:175], a[52:55], v[68:71]
    v_cndmask_b32 v92, v82, v80, s[66:67]
    v_cndmask_b32 v93, v83, v81, s[66:67]
    v_cndmask_b32 v94, v84, v82, s[66:67]
    v_mfma_f32_16x16x32_bf16 v[72:75], a[188:191], a[92:95], v[72:75]
    v_cndmask_b32 v95, v85, v83, s[66:67]
    v_mfma_f32_16x16x32_bf16 v[76:79], a[188:191], a[60:63], v[76:79]
    s_waitcnt lgkmcnt(0)
    ds_write_b128 v8, v[88:91] offset:0
    ds_write_b128 v9, v[92:95] offset:0
    v_mfma_f32_16x16x32_bf16 v[48:51], a[128:131], a[48:51], 0
    v_mfma_f32_16x16x32_bf16 v[52:55], a[128:131], a[64:67], 0
    s_nop 0
    v_add_f32 v104, v64, v72
    v_mfma_f32_16x16x32_bf16 v[56:59], a[144:147], a[56:59], 0
    v_add_f32 v105, v65, v73
    v_add_f32 v106, v66, v74
    v_mfma_f32_16x16x32_bf16 v[60:63], a[144:147], a[72:75], 0
    v_add_f32 v107, v67, v75
    v_add_f32 v108, v68, v76
    v_add_f32 v109, v69, v77
    v_mfma_f32_16x16x32_bf16 v[48:51], a[132:135], a[80:83], v[48:51]
    s_waitcnt lgkmcnt(0)
    ds_read_b128 v[96:99], v10 offset:0
    ds_read_b128 v[100:103], v10 offset:1024
    v_add_f32 v110, v70, v78
    v_mfma_f32_16x16x32_bf16 v[52:55], a[132:135], a[48:51], v[52:55]
    v_add_f32 v111, v71, v79
    v_sub_f32 v64, v64, v72
    v_sub_f32 v65, v65, v73
    v_mfma_f32_16x16x32_bf16 v[56:59], a[148:151], a[88:91], v[56:59]
    v_sub_f32 v66, v66, v74
    v_sub_f32 v67, v67, v75
    v_mfma_f32_16x16x32_bf16 v[60:63], a[148:151], a[56:59], v[60:63]
    v_sub_f32 v68, v68, v76
    v_sub_f32 v69, v69, v77
    v_sub_f32 v70, v70, v78
    v_mfma_f32_16x16x32_bf16 v[48:51], a[136:139], a[52:55], v[48:51]
    v_sub_f32 v71, v71, v79
    v_cvt_pk_bf16_f32 v112, v104, v105
    v_mfma_f32_16x16x32_bf16 v[52:55], a[136:139], a[68:71], v[52:55]
    v_cvt_pk_bf16_f32 v113, v106, v107
    v_cvt_pk_bf16_f32 v114, v108, v109
    v_cvt_pk_bf16_f32 v115, v110, v111
    v_mfma_f32_16x16x32_bf16 v[56:59], a[152:155], a[60:63], v[56:59]
    v_cvt_pk_bf16_f32 v104, v64, v65
    v_cvt_pk_bf16_f32 v105, v66, v67
    v_cvt_pk_bf16_f32 v106, v68, v69
    v_mfma_f32_16x16x32_bf16 v[60:63], a[152:155], a[76:79], v[60:63]
    v_cvt_pk_bf16_f32 v107, v70, v71
    v_cvt_pk_bf16_f32 v108, -v64, -v65
    v_mfma_f32_16x16x32_bf16 v[48:51], a[140:143], a[84:87], v[48:51]
    v_cvt_pk_bf16_f32 v109, -v66, -v67
    v_cndmask_b32 v116, v106, v104, s[66:67]
    v_cndmask_b32 v117, v107, v105, s[66:67]
    v_mfma_f32_16x16x32_bf16 v[52:55], a[140:143], a[52:55], v[52:55]
    v_cndmask_b32 v118, v108, v106, s[66:67]
    v_cndmask_b32 v119, v109, v107, s[66:67]
    v_mfma_f32_16x16x32_bf16 v[56:59], a[156:159], a[92:95], v[56:59]
    ds_write_b128 v8, v[112:115] offset:2048
    v_mfma_f32_16x16x32_bf16 v[60:63], a[156:159], a[60:63], v[60:63]
    ds_write_b128 v9, v[116:119] offset:2048
    s_add_u32 s62, s4, 8192
    s_waitcnt lgkmcnt(3)
    buffer_store_dwordx4 v[96:99], v11, s[36:39], s62 offen sc1
    s_waitcnt lgkmcnt(2)
    buffer_store_dwordx4 v[100:103], v13, s[36:39], s62 offen sc1
    s_waitcnt lgkmcnt(0)
    ds_read_b128 v[120:123], v10 offset:2048
    ds_read_b128 v[124:127], v10 offset:3072
    v_add_f32 v80, v48, v56
    v_add_f32 v81, v49, v57
    v_add_f32 v82, v50, v58
    v_add_f32 v83, v51, v59
    v_add_f32 v84, v52, v60
    v_add_f32 v85, v53, v61
    v_add_f32 v86, v54, v62
    v_add_f32 v87, v55, v63
    v_sub_f32 v48, v48, v56
    v_sub_f32 v49, v49, v57
    v_sub_f32 v50, v50, v58
    v_sub_f32 v51, v51, v59
    v_sub_f32 v52, v52, v60
    v_sub_f32 v53, v53, v61
    v_sub_f32 v54, v54, v62
    v_sub_f32 v55, v55, v63
    v_cvt_pk_bf16_f32 v88, v80, v81
    v_cvt_pk_bf16_f32 v89, v82, v83
    v_cvt_pk_bf16_f32 v90, v84, v85
    v_cvt_pk_bf16_f32 v91, v86, v87
    v_cvt_pk_bf16_f32 v80, v48, v49
    v_cvt_pk_bf16_f32 v81, v50, v51
    v_cvt_pk_bf16_f32 v82, v52, v53
    v_cvt_pk_bf16_f32 v83, v54, v55
    v_cvt_pk_bf16_f32 v84, -v48, -v49
    v_cvt_pk_bf16_f32 v85, -v50, -v51
    v_cndmask_b32 v92, v82, v80, s[66:67]
    v_cndmask_b32 v93, v83, v81, s[66:67]
    v_cndmask_b32 v94, v84, v82, s[66:67]
    v_cndmask_b32 v95, v85, v83, s[66:67]
    ds_write_b128 v8, v[88:91] offset:0
    ds_write_b128 v9, v[92:95] offset:0
    s_add_u32 s62, s4, 10240
    s_waitcnt lgkmcnt(3)
    buffer_store_dwordx4 v[120:123], v11, s[36:39], s62 offen sc1
    s_waitcnt lgkmcnt(2)
    buffer_store_dwordx4 v[124:127], v13, s[36:39], s62 offen sc1
    s_waitcnt lgkmcnt(0)
    ds_read_b128 v[96:99], v10 offset:0
    ds_read_b128 v[100:103], v10 offset:1024
    s_add_u32 s62, s4, 12288
    s_waitcnt lgkmcnt(1)
    buffer_store_dwordx4 v[96:99], v11, s[36:39], s62 offen sc1
    s_waitcnt lgkmcnt(0)
    buffer_store_dwordx4 v[100:103], v13, s[36:39], s62 offen sc1
    v_mov_b32 v14, 0
    v_mov_b32 v15, 1
    s_waitcnt vmcnt(0)
    s_mov_b64 exec, 1
    buffer_store_dword v15, v14, s[36:39], s5 offen sc1
    s_mov_b64 exec, -1
    s_endpgm
L_slow_z:
    s_mov_b32 s3, 0
L_retry_z:
    s_sleep 3
    buffer_load_dword v17, v18, s[44:47], 0 offen offset:128 sc1
    s_waitcnt vmcnt(0)
    v_cmp_eq_u32 vcc, 0, v17
    s_add_u32 s3, s3, 1
    s_cbranch_vccz L_ok_z
    s_cmp_lt_u32 s3, 50000
    s_cbranch_scc1 L_retry_z
    s_branch L_ok_z
L_slow_w:
    s_mov_b32 s3, 0
L_retry_w:
    s_sleep 3
    buffer_load_dword v27, v18, s[36:39], s4 offen sc1
    s_waitcnt vmcnt(0)
    v_cmp_eq_u32 vcc, 0, v27
    s_add_u32 s3, s3, 1
    s_cbranch_vccz L_ok_w
    s_cmp_lt_u32 s3, 50000
    s_cbranch_scc1 L_retry_w
    s_branch L_ok_w
L_slow_h0:
    s_mov_b32 s3, 0
L_retry_h0:
    s_sleep 3
    buffer_load_dword v27, v17, s[36:39], s65 offen sc1
    s_waitcnt vmcnt(0)
    v_cmp_eq_u32 vcc, 0, v27
    s_add_u32 s3, s3, 1
    s_cbranch_vccz L_ok_h0
    s_cmp_lt_u32 s3, 50000
    s_cbranch_scc1 L_retry_h0
    s_branch L_ok_h0
L_slow_h1:
    s_mov_b32 s3, 0
L_retry_h1:
    s_sleep 3
    buffer_load_dword v27, v17, s[36:39], s65 offen sc1
    s_waitcnt vmcnt(0)
    v_cmp_eq_u32 vcc, 0, v27
    s_add_u32 s3, s3, 1
    s_cbranch_vccz L_ok_h1
    s_cmp_lt_u32 s3, 50000
    s_cbranch_scc1 L_retry_h1
    s_branch L_ok_h1
L_slow_h2:
    s_mov_b32 s3, 0
L_retry_h2:
    s_sleep 3
    buffer_load_dword v27, v17, s[36:39], s65 offen sc1
    s_waitcnt vmcnt(0)
    v_cmp_eq_u32 vcc, 0, v27
    s_add_u32 s3, s3, 1
    s_cbranch_vccz L_ok_h2
    s_cmp_lt_u32 s3, 50000
    s_cbranch_scc1 L_retry_h2
    s_branch L_ok_h2
L_slow_h3:
    s_mov_b32 s3, 0
L_retry_h3:
    s_sleep 3
    buffer_load_dword v27, v17, s[36:39], s65 offen sc1
    s_waitcnt vmcnt(0)
    v_cmp_eq_u32 vcc, 0, v27
    s_add_u32 s3, s3, 1
    s_cbranch_vccz L_ok_h3
    s_cmp_lt_u32 s3, 50000
    s_cbranch_scc1 L_retry_h3
    s_branch L_ok_h3
L_slow_t0:
    s_mov_b32 s3, 0
L_retry_t0:
    s_sleep 3
    buffer_load_dword v5, v18, s[36:39], s49 offen sc1
    s_waitcnt vmcnt(0)
    v_cmp_eq_u32 vcc, 0, v5
    s_add_u32 s3, s3, 1
    s_cbranch_vccz L_ok_t0
    s_cmp_lt_u32 s3, 50000
    s_cbranch_scc1 L_retry_t0
    s_branch L_ok_t0
L_slow_t1:
    s_mov_b32 s3, 0
L_retry_t1:
    s_sleep 3
    buffer_load_dword v5, v18, s[36:39], s49 offen sc1
    s_waitcnt vmcnt(0)
    v_cmp_eq_u32 vcc, 0, v5
    s_add_u32 s3, s3, 1
    s_cbranch_vccz L_ok_t1
    s_cmp_lt_u32 s3, 50000
    s_cbranch_scc1 L_retry_t1
    s_branch L_ok_t1
L_slow_az:
    s_mov_b32 s3, 0
L_retry_az:
    s_sleep 3
    buffer_load_dword v29, v28, s[44:47], 0 offen offset:128 sc1
    s_waitcnt vmcnt(0)
    v_cmp_eq_u32 vcc, 0, v29
    s_add_u32 s3, s3, 1
    s_cbranch_vccz L_ok_az
    s_cmp_lt_u32 s3, 50000
    s_cbranch_scc1 L_retry_az
    s_branch L_ok_az
L_slow_ay:
    s_mov_b32 s3, 0
L_retry_ay:
    s_sleep 3
    buffer_load_dword v29, v3, s[36:39], s70 offen sc1
    buffer_load_dword v30, v4, s[36:39], s70 offen sc1
    s_waitcnt vmcnt(0)
    v_min_u32 v29, v29, v30
    v_cmp_eq_u32 vcc, 0, v29
    s_add_u32 s3, s3, 1
    s_cbranch_vccz L_ok_ay
    s_cmp_lt_u32 s3, 50000
    s_cbranch_scc1 L_retry_ay
    s_branch L_ok_ay
L_code_end:
.section .rodata,"a"
.p2align 6
.amdhsa_kernel recurrent_scan__spectral_gfnet__glu_gated_swiglu__prompt_kernel
  .amdhsa_next_free_vgpr 512
  .amdhsa_next_free_sgpr 102
  .amdhsa_accum_offset 256
  .amdhsa_group_segment_fixed_size 0
  .amdhsa_kernarg_size 80
  .amdhsa_user_sgpr_count 2
  .amdhsa_user_sgpr_kernarg_segment_ptr 1
  .amdhsa_system_sgpr_workgroup_id_x 1
.end_amdhsa_kernel
.p2align 8
TABS:
.long 0x3f80,0x3f80,0x3f80,0x3f80,0x3f800000,0xbe483f7b,0xbf353f35,0xbf553f0e
.long 0x3f80,0xbec43f6d,0xbf800000,0xbf6dbec4,0x3f800000,0xbf0e3f55,0xbf35bf35,0xbe48bf7b
.long 0x3f80,0xbf353f35,0xbf80,0x3f35bf35,0x3f800000,0xbf553f0e,0x3f35bf35,0x3f7b3e48
.long 0x3f80,0xbf6d3ec4,0x3f800000,0x3ec43f6d,0x3f800000,0xbf7b3e48,0x3f353f35,0xbf0e3f55
.long 0x3f80,0xbf800000,0x3f80,0xbf800000,0x3f800000,0xbf7bbe48,0xbf353f35,0xbf0ebf55
.long 0x3f80,0xbf6dbec4,0xbf800000,0x3ec4bf6d,0x3f800000,0xbf55bf0e,0xbf35bf35,0x3f7bbe48
.long 0x3f80,0xbf35bf35,0xbf80,0x3f353f35,0x3f800000,0xbf0ebf55,0x3f35bf35,0xbe483f7b
.long 0x3f80,0xbec4bf6d,0x3f800000,0xbf6d3ec4,0x3f800000,0xbe48bf7b,0x3f353f35,0xbf55bf0e
.long 0x3f80,0xbf80,0x3f80,0xbf80,0x3f800000,0x3e48bf7b,0xbf353f35,0x3f55bf0e
.long 0x3f80,0x3ec4bf6d,0xbf800000,0x3f6d3ec4,0x3f800000,0x3f0ebf55,0xbf35bf35,0x3e483f7b
.long 0x3f80,0x3f35bf35,0xbf80,0xbf353f35,0x3f800000,0x3f55bf0e,0x3f35bf35,0xbf7bbe48
.long 0x3f80,0x3f6dbec4,0x3f800000,0xbec4bf6d,0x3f800000,0x3f7bbe48,0x3f353f35,0x3f0ebf55
.long 0x3f80,0x3f800000,0x3f80,0x3f800000,0x3f800000,0x3f7b3e48,0xbf353f35,0x3f0e3f55
.long 0x3f80,0x3f6d3ec4,0xbf800000,0xbec43f6d,0x3f800000,0x3f553f0e,0xbf35bf35,0xbf7b3e48
.long 0x3f80,0x3f353f35,0xbf80,0xbf35bf35,0x3f800000,0x3f0e3f55,0x3f35bf35,0x3e48bf7b
.long 0x3f80,0x3ec43f6d,0x3f800000,0x3f6dbec4,0x3f800000,0x3e483f7b,0x3f353f35,0x3f553f0e
.long 0x3f80,0x3f80,0x3f80,0x3f80,0xbec43f6d,0xbf0e3f55,0xbf6d3ec4,0xbf7b3e48
.long 0xbf353f35,0xbf6d3ec4,0xbf35bf35,0xbec4bf6d,0xbf6d3ec4,0xbf7bbe48,0x3ec4bf6d,0x3f55bf0e
.long 0xbf800000,0xbf35bf35,0x3f800000,0x3f353f35,0xbf6dbec4,0xbe48bf7b,0x3ec43f6d,0xbf0e3f55
.long 0xbf35bf35,0x3ec4bf6d,0xbf353f35,0xbf6dbec4,0xbec4bf6d,0x3f55bf0e,0xbf6dbec4,0x3e48bf7b
.long 0xbf80,0x3f800000,0xbf80,0x3f800000,0x3ec4bf6d,0x3f553f0e,0x3f6dbec4,0x3e483f7b
.long 0x3f35bf35,0x3ec43f6d,0x3f353f35,0xbf6d3ec4,0x3f6dbec4,0xbe483f7b,0xbec43f6d,0xbf0ebf55
.long 0x3f800000,0xbf353f35,0xbf800000,0x3f35bf35,0x3f6d3ec4,0xbf7b3e48,0xbec4bf6d,0x3f553f0e
.long 0x3f353f35,0xbf6dbec4,0x3f35bf35,0xbec43f6d,0x3ec43f6d,0xbf0ebf55,0x3f6d3ec4,0xbf7bbe48
.long 0x3f80,0xbf80,0x3f80,0xbf80,0xbec43f6d,0x3f0ebf55,0xbf6d3ec4,0x3f7bbe48
.long 0xbf353f35,0x3f6dbec4,0xbf35bf35,0x3ec43f6d,0xbf6d3ec4,0x3f7b3e48,0x3ec4bf6d,0xbf553f0e
.long 0xbf800000,0x3f353f35,0x3f800000,0xbf35bf35,0xbf6dbec4,0x3e483f7b,0x3ec43f6d,0x3f0ebf55
.long 0xbf35bf35,0xbec43f6d,0xbf353f35,0x3f6d3ec4,0xbec4bf6d,0xbf553f0e,0xbf6dbec4,0xbe483f7b
.long 0xbf80,0xbf800000,0xbf80,0xbf800000,0x3ec4bf6d,0xbf55bf0e,0x3f6dbec4,0xbe48bf7b
.long 0x3f35bf35,0xbec4bf6d,0x3f353f35,0x3f6dbec4,0x3f6dbec4,0x3e48bf7b,0xbec43f6d,0x3f0e3f55
.long 0x3f800000,0x3f35bf35,0xbf800000,0xbf353f35,0x3f6d3ec4,0x3f7bbe48,0xbec4bf6d,0xbf55bf0e
.long 0x3f353f35,0x3f6d3ec4,0x3f35bf35,0x3ec4bf6d,0x3ec43f6d,0x3f0e3f55,0x3f6d3ec4,0x3f7b3e48
.long 0x3f80,0x3f80,0x3f80,0x3f80,0xbf800000,0xbf7bbe48,0xbf35bf35,0xbf0ebf55
.long 0xbf80,0x3ec4bf6d,0x3f800000,0x3f6d3ec4,0x3f800000,0x3f553f0e,0xbf353f35,0xbf7b3e48
.long 0x3f80,0xbf353f35,0xbf80,0x3f35bf35,0xbf800000,0xbf0ebf55,0x3f353f35,0xbe483f7b
.long 0xbf80,0x3f6dbec4,0xbf800000,0xbec4bf6d,0x3f800000,0x3e483f7b,0x3f35bf35,0x3f553f0e
.long 0x3f80,0xbf800000,0x3f80,0xbf800000,0xbf800000,0x3e48bf7b,0xbf35bf35,0x3f55bf0e
.long 0xbf80,0x3f6d3ec4,0x3f800000,0xbec43f6d,0x3f800000,0xbf0e3f55,0xbf353f35,0xbe48bf7b
.long 0x3f80,0xbf35bf35,0xbf80,0x3f353f35,0xbf800000,0x3f55bf0e,0x3f353f35,0xbf7bbe48
.long 0xbf80,0x3ec43f6d,0xbf800000,0x3f6dbec4,0x3f800000,0xbf7b3e48,0x3f35bf35,0xbf0e3f55
.long 0x3f80,0xbf80,0x3f80,0xbf80,0xbf800000,0x3f7b3e48,0xbf35bf35,0x3f0e3f55
.long 0xbf80,0xbec43f6d,0x3f800000,0xbf6dbec4,0x3f800000,0xbf55bf0e,0xbf353f35,0x3f7bbe48
.long 0x3f80,0x3f35bf35,0xbf80,0xbf353f35,0xbf800000,0x3f0e3f55,0x3f353f35,0x3e48bf7b
.long 0xbf80,0xbf6d3ec4,0xbf800000,0x3ec43f6d,0x3f800000,0xbe48bf7b,0x3f35bf35,0xbf55bf0e
.long 0x3f80,0x3f800000,0x3f80,0x3f800000,0xbf800000,0xbe483f7b,0xbf35bf35,0xbf553f0e
.long 0xbf80,0xbf6dbec4,0x3f800000,0x3ec4bf6d,0x3f800000,0x3f0ebf55,0xbf353f35,0x3e483f7b
.long 0x3f80,0x3f353f35,0xbf80,0xbf35bf35,0xbf800000,0xbf553f0e,0x3f353f35,0x3f7b3e48
.long 0xbf80,0xbec4bf6d,0xbf800000,0xbf6d3ec4,0x3f800000,0x3f7bbe48,0x3f35bf35,0x3f0ebf55
.long 0x3f80,0x3f80,0x3f80,0x3f80,0xbf6dbec4,0xbf55bf0e,0xbec4bf6d,0xbe48bf7b
.long 0x3f35bf35,0x3f6dbec4,0x3f353f35,0x3ec43f6d,0x3ec43f6d,0xbe483f7b,0xbf6dbec4,0xbf0ebf55
.long 0xbf800000,0xbf35bf35,0x3f800000,0x3f353f35,0x3ec4bf6d,0x3f7bbe48,0xbf6d3ec4,0xbf55bf0e
.long 0x3f353f35,0xbec43f6d,0x3f35bf35,0x3f6d3ec4,0xbf6d3ec4,0xbf0ebf55,0xbec43f6d,0xbf7bbe48
.long 0xbf80,0x3f800000,0xbf80,0x3f800000,0x3f6d3ec4,0xbf0e3f55,0x3ec43f6d,0xbf7b3e48
.long 0xbf353f35,0xbec4bf6d,0xbf35bf35,0x3f6dbec4,0xbec4bf6d,0x3f7b3e48,0x3f6d3ec4,0xbf553f0e
.long 0x3f800000,0xbf353f35,0xbf800000,0x3f35bf35,0xbec43f6d,0xbe48bf7b,0x3f6dbec4,0xbf0e3f55
.long 0xbf35bf35,0x3f6d3ec4,0xbf353f35,0x3ec4bf6d,0x3f6dbec4,0xbf553f0e,0x3ec4bf6d,0xbe483f7b
.long 0x3f80,0xbf80,0x3f80,0xbf80,0xbf6dbec4,0x3f553f0e,0xbec4bf6d,0x3e483f7b
.long 0x3f35bf35,0xbf6d3ec4,0x3f353f35,0xbec4bf6d,0x3ec43f6d,0x3e48bf7b,0xbf6dbec4,0x3f0e3f55
.long 0xbf800000,0x3f353f35,0x3f800000,0xbf35bf35,0x3ec4bf6d,0xbf7b3e48,0xbf6d3ec4,0x3f553f0e
.long 0x3f353f35,0x3ec4bf6d,0x3f35bf35,0xbf6dbec4,0xbf6d3ec4,0x3f0e3f55,0xbec43f6d,0x3f7b3e48
.long 0xbf80,0xbf800000,0xbf80,0xbf800000,0x3f6d3ec4,0x3f0ebf55,0x3ec43f6d,0x3f7bbe48
.long 0xbf353f35,0x3ec43f6d,0xbf35bf35,0xbf6d3ec4,0xbec4bf6d,0xbf7bbe48,0x3f6d3ec4,0x3f55bf0e
.long 0x3f800000,0x3f35bf35,0xbf800000,0xbf353f35,0xbec43f6d,0x3e483f7b,0x3f6dbec4,0x3f0ebf55
.long 0xbf35bf35,0xbf6dbec4,0xbf353f35,0xbec43f6d,0x3f6dbec4,0x3f55bf0e,0x3ec4bf6d,0x3e48bf7b
.long 0x3f80,0x0,0x0,0x0,0x3f800000,0x0,0x0,0x0
.long 0x0,0x3f80,0x0,0x0,0x0,0x3f800000,0x0,0x0
.long 0x0,0x0,0x0,0x0,0x0,0x0,0x0,0x0
.long 0x0,0x0,0x0,0x0,0x0,0x0,0x0,0x0
.long 0x0,0x0,0x3f80,0x0,0x0,0x0,0x3f800000,0x0
.long 0x0,0x0,0x0,0x3f80,0x0,0x0,0x0,0x3f800000
.long 0x0,0x0,0x0,0x0,0x0,0x0,0x0,0x0
.long 0x0,0x0,0x0,0x0,0x0,0x0,0x0,0x0
.long 0x0,0x0,0x0,0x0,0x0,0x0,0x0,0x0
.long 0x0,0x0,0x0,0x0,0x0,0x0,0x0,0x0
.long 0x0,0x0,0x0,0x0,0x0,0x0,0x0,0x0
.long 0x0,0x0,0x0,0x0,0x0,0x0,0x0,0x0
.long 0x0,0x0,0x0,0x0,0x0,0x0,0x0,0x0
.long 0x0,0x0,0x0,0x0,0x0,0x0,0x0,0x0
.long 0x0,0x0,0x0,0x0,0x0,0x0,0x0,0x0
.long 0x0,0x0,0x0,0x0,0x0,0x0,0x0,0x0
.long 0x0,0x0,0x0,0x0,0x0,0x0,0x0,0x0
.long 0x0,0x0,0x0,0x0,0x0,0x0,0x0,0x0
.long 0x3f80,0x0,0x0,0x0,0x3f800000,0x0,0x0,0x0
.long 0x0,0x3f80,0x0,0x0,0x0,0x3f800000,0x0,0x0
.long 0x0,0x0,0x0,0x0,0x0,0x0,0x0,0x0
.long 0x0,0x0,0x0,0x0,0x0,0x0,0x0,0x0
.long 0x0,0x0,0x3f80,0x0,0x0,0x0,0x3f800000,0x0
.long 0x0,0x0,0x0,0x3f80,0x0,0x0,0x0,0x3f800000
.long 0x0,0x0,0x0,0x0,0x0,0x0,0x0,0x0
.long 0x0,0x0,0x0,0x0,0x0,0x0,0x0,0x0
.long 0x0,0x0,0x0,0x0,0x0,0x0,0x0,0x0
.long 0x0,0x0,0x0,0x0,0x0,0x0,0x0,0x0
.long 0x0,0x0,0x0,0x0,0x0,0x0,0x0,0x0
.long 0x0,0x0,0x0,0x0,0x0,0x0,0x0,0x0
.long 0x0,0x0,0x0,0x0,0x0,0x0,0x0,0x0
.long 0x0,0x0,0x0,0x0,0x0,0x0,0x0,0x0
.long 0x0,0x0,0x0,0x0,0x0,0x0,0x0,0x0
.long 0x0,0x0,0x0,0x0,0x0,0x0,0x0,0x0
.long 0x0,0x0,0x0,0x0,0x0,0x0,0x0,0x0
.long 0x0,0x0,0x0,0x0,0x0,0x0,0x0,0x0
.long 0x0,0x0,0x0,0x0,0x0,0x0,0x0,0x0
.long 0x0,0x0,0x0,0x0,0x0,0x0,0x0,0x0
.long 0x0,0x0,0x0,0x0,0x0,0x0,0x0,0x0
.long 0x0,0x0,0x0,0x0,0x0,0x0,0x0,0x0
.long 0x3f80,0x0,0x0,0x0,0x3f800000,0x0,0x0,0x0
.long 0x0,0x3f80,0x0,0x0,0x0,0x3f800000,0x0,0x0
.long 0x0,0x0,0x0,0x0,0x0,0x0,0x0,0x0
.long 0x0,0x0,0x0,0x0,0x0,0x0,0x0,0x0
.long 0x0,0x0,0x3f80,0x0,0x0,0x0,0x3f800000,0x0
.long 0x0,0x0,0x0,0x3f80,0x0,0x0,0x0,0x3f800000
.long 0x0,0x0,0x0,0x0,0x0,0x0,0x0,0x0
.long 0x0,0x0,0x0,0x0,0x0,0x0,0x0,0x0
.long 0x0,0x0,0x0,0x0,0x0,0x0,0x0,0x0
.long 0x0,0x0,0x0,0x0,0x0,0x0,0x0,0x0
.long 0x0,0x0,0x0,0x0,0x0,0x0,0x0,0x0
.long 0x0,0x0,0x0,0x0,0x0,0x0,0x0,0x0
.long 0x0,0x0,0x0,0x0,0x0,0x0,0x0,0x0
.long 0x0,0x0,0x0,0x0,0x0,0x0,0x0,0x0
.long 0x0,0x0,0x0,0x0,0x0,0x0,0x0,0x0
.long 0x0,0x0,0x0,0x0,0x0,0x0,0x0,0x0
.long 0x0,0x0,0x0,0x0,0x0,0x0,0x0,0x0
.long 0x0,0x0,0x0,0x0,0x0,0x0,0x0,0x0
.long 0x3f80,0x0,0x0,0x0,0x3f800000,0x0,0x0,0x0
.long 0x0,0x3f80,0x0,0x0,0x0,0x3f800000,0x0,0x0
.long 0x0,0x0,0x0,0x0,0x0,0x0,0x0,0x0
.long 0x0,0x0,0x0,0x0,0x0,0x0,0x0,0x0
.long 0x0,0x0,0x3f80,0x0,0x0,0x0,0x3f800000,0x0
.long 0x0,0x0,0x0,0x3f80,0x0,0x0,0x0,0x3f800000
```
